```python
import torch

def _softmax(x, axis=-1):
    return torch.softmax(x, dim=axis)
def _gelu(x):
    return torch.nn.functional.gelu(x, approximate="tanh")
def _silu(x):
    return torch.nn.functional.silu(x)
def _sigmoid(x):
    return torch.sigmoid(x)
def _layernorm(x, axis=-1, eps=1e-5):
    m = x.mean(dim=axis, keepdim=True)
    v = x.var(dim=axis, keepdim=True, unbiased=False)
    return (x - m) / torch.sqrt(v + eps)
def _scatter_add(tgt, idx, src, axis=0):
    return tgt.clone().index_add_(axis, idx, src)
def _segment_sum(src, seg, n):
    out = torch.zeros((n,) + src.shape[1:], dtype=src.dtype)
    return out.index_add_(0, seg, src)
def _pad(x, pw):
    flat = tuple(v for pair in reversed(pw) for v in pair)
    return torch.nn.functional.pad(x, flat)

kernel_name = 'gated_mix__sliding_block__mixer_channel_mlp__prompt'

def setup_inputs():

    _w = (lambda a: (lambda t: t.to(torch.bfloat16) if t.is_floating_point() else t)(torch.as_tensor(a)))
    def _A_setup():
        B, S, D = 1, 2048, 640
        return {
            "x": _w((lambda *s: torch.randn(*s, dtype=torch.bfloat16) * 0.05)(B, S, D)),
            "wqkv": _w((lambda *s: torch.randn(*s, dtype=torch.bfloat16) * 0.8)(D, 3 * D)),
            "wo": _w((lambda *s: torch.randn(*s, dtype=torch.bfloat16) * 0.05)(D, D)),
        }
    _A_in = _A_setup()

    def _B_setup():
        B, S, D, F = 1, 2048, 640, 1728
        return {
            "x": _w((lambda *s: torch.randn(*s, dtype=torch.bfloat16) * 0.05)(B, S, D)),
            "w1": _w((lambda *s: torch.randn(*s, dtype=torch.bfloat16) * 3.2)(D, F) * (D ** -0.5)),
            "b1": _w((lambda *s: torch.randn(*s, dtype=torch.bfloat16) * 1.6)(F)),
            "w2": _w((lambda *s: torch.randn(*s, dtype=torch.bfloat16) * 0.2)(F, D) * (F ** -0.5)),
            "b2": _w((lambda *s: torch.randn(*s, dtype=torch.bfloat16) * 0.2)(D)),
        }
    _B_in = _B_setup()

    return {
        "A_x": _A_in["x"],
        "A_wqkv": _A_in["wqkv"],
        "A_wo": _A_in["wo"],
        "B_x": _B_in["x"],
        "B_w1": _B_in["w1"],
        "B_b1": _B_in["b1"],
        "B_w2": _B_in["w2"],
        "B_b2": _B_in["b2"],
        "gate_w": _w((lambda *s: torch.randn(*s, dtype=torch.bfloat16) * 0.05)(640) * 16.0),
    }

def reference(A_x, A_wqkv, A_wo, B_x, B_w1, B_b1, B_w2, B_b2, gate_w):
    def _A_ref(x, wqkv, wo):
        B, S, D = x.shape
        H = 32; Dh = D // H; W = 256
        qkv = (lambda x, *d: x.permute(*d))((x @ wqkv).reshape(B, S, 3, H, Dh), 2, 0, 3, 1, 4)
        q, k, v = qkv[0], qkv[1], qkv[2]
        scores = torch.einsum("bhqd,bhkd->bhqk", q, k) * (Dh ** -0.5)
        idx = torch.arange(S)
        mask = (idx[:, None] - idx[None, :] >= 0) & (idx[:, None] - idx[None, :] < W)
        scores = torch.where(mask[None, None], scores, -1e9)
        p = _softmax(scores, axis=-1)
        o = torch.einsum("bhqk,bhkd->bhqd", p, v)
        return (lambda x, *d: x.permute(*d))(o, 0, 2, 1, 3).reshape(B, S, D) @ wo

    def _B_ref(x, w1, b1, w2, b2):
        y = _layernorm(x, axis=-1)
        h = _gelu(torch.einsum("bsd,df->bsf", y, w1) + b1)
        return torch.einsum("bsf,fd->bsd", h, w2) + b2

    x = A_x
    g = _sigmoid((x * gate_w).sum(-1, keepdims=True))
    a = _A_ref(x, A_wqkv, A_wo)
    b = _B_ref(x, B_w1, B_b1, B_w2, B_b2)
    return g * a + (1 - g) * b
```

```asm
; @launch grid=(256,1,1) block=(512,1,1) lds=163840
.amdgcn_target "amdgcn-amd-amdhsa--gfx950"
.text
.globl gated_mix__sliding_block__mixer_channel_mlp__prompt_kernel
.p2align 8
.type gated_mix__sliding_block__mixer_channel_mlp__prompt_kernel,@function
gated_mix__sliding_block__mixer_channel_mlp__prompt_kernel:
    s_cmp_ge_u32 s2, 256
    s_cbranch_scc1 L_end
    s_load_dwordx16 s[4:19], s[0:1], 0
    s_load_dwordx8 s[20:27], s[0:1], 64
    v_lshrrev_b32 v2, 6, v0
    v_and_b32 v1, 63, v0
    v_readfirstlane_b32 s44, v2
    s_and_b32 s46, s2, 7
    s_lshr_b32 s47, s2, 3
    s_cmp_lg_u32 s44, 3
    s_cbranch_scc1 cp_1_skip
    s_getpc_b64 s[52:53]
cp_1:
    s_and_b32 s48, s47, 7
    s_lshl_b32 s48, s48, 13
    v_lshlrev_b32 v251, 7, v1
    v_add_u32 v251, s48, v251
    v_min_u32 v251, L_end-cp_1-4, v251
    global_load_dword v251, v251, s[52:53]
cp_1_skip:
    s_lshr_b32 s48, s46, 2
    s_lshl_b32 s48, s48, 3
    s_and_b32 s49, s47, 7
    s_add_u32 s56, s48, s49
    s_and_b32 s48, s46, 3
    s_lshl_b32 s48, s48, 2
    s_lshr_b32 s49, s47, 3
    s_add_u32 s57, s48, s49
    s_and_b32 s90, s44, 3
    s_cmp_ge_u32 s57, 15
    s_cbranch_scc1 s1_idle
    s_lshl_b32 s48, s56, 7
    s_lshr_b32 s49, s90, 1
    s_lshl_b32 s49, s49, 6
    s_add_u32 s48, s48, s49
    s_and_b32 s49, s90, 1
    s_add_u32 s48, s48, s49
    v_lshrrev_b32 v26, 3, v1
    v_lshlrev_b32 v26, 1, v26
    v_add_u32 v26, s48, v26
    s_movk_i32 s50, 1280
    v_mul_lo_u32 v26, v26, s50
    v_lshrrev_b32 v27, 4, v1
    v_and_b32 v28, 7, v1
    v_xor_b32 v28, v28, v27
    v_xor_b32 v29, 4, v28
    v_lshl_add_u32 v2, v28, 4, v26
    v_lshl_add_u32 v3, v29, 4, v26
    v_add_u32 v3, 19456, v3
    v_lshl_add_u32 v4, v28, 4, v26
    v_add_u32 v4, 38912, v4
    v_lshl_add_u32 v5, v29, 4, v26
    v_add_u32 v5, 58368, v5
    s_lshl_b32 s48, s90, 4
    v_lshrrev_b32 v26, 4, v1
    v_add_u32 v27, s48, v26
    v_bfe_u32 v28, v1, 2, 2
    v_xor_b32 v28, v28, v26
    v_and_b32 v29, 3, v1
    v_lshl_add_u32 v28, v28, 2, v29
    v_lshlrev_b32 v28, 4, v28
    s_lshl_b32 s48, s57, 8
    v_add_u32 v28, s48, v28
    s_movk_i32 s50, 3840
    v_mul_lo_u32 v29, v27, s50
    v_add_u32 v6, v29, v28
    v_add_u32 v7, 14336, v6
    v_add_u32 v8, 28672, v6
    v_add_u32 v9, 43008, v6
    s_movk_i32 s50, 3456
    v_mul_lo_u32 v29, v27, s50
    v_add_u32 v10, v29, v28
    v_add_u32 v11, 12800, v10
    v_add_u32 v12, 25600, v10
    v_add_u32 v13, 38400, v10
    s_lshl_b32 s68, s90, 12
    s_lshr_b32 s48, s47, 3
    s_mul_i32 s48, s48, 10
    s_and_b32 s49, s47, 7
    s_mul_i32 s49, s49, 5
    s_add_u32 s48, s48, s49
    s_lshr_b32 s48, s48, 2
    s_sub_u32 s49, s48, 10
    s_cmp_ge_u32 s48, 10
    s_cselect_b32 s48, s49, s48
    s_add_u32 s49, s48, 9
    s_sub_u32 s50, s49, 10
    s_cmp_ge_u32 s49, 10
    s_cselect_b32 s49, s50, s49
    s_add_u32 s51, s48, 6
    s_sub_u32 s50, s51, 10
    s_cmp_ge_u32 s51, 10
    s_cselect_b32 s51, s50, s51
    s_cmp_ge_u32 s44, 4
    s_cselect_b32 s49, s51, s49
    s_mul_i32 s80, s49, 221184
    s_lshl_b32 s58, s48, 7
    s_mul_i32 s59, s48, 245760
    s_waitcnt lgkmcnt(0)
    s_mov_b32 s28, s4
    s_and_b32 s29, s5, 0xffff
    s_mov_b32 s30, 2621440
    s_mov_b32 s31, 0x20000
    s_mov_b32 s32, s6
    s_and_b32 s33, s7, 0xffff
    s_mov_b32 s34, 2457600
    s_mov_b32 s35, 0x20000
    s_cmp_lt_u32 s44, 4
    s_cbranch_scc1 s1_nodma
    s_add_u32 m0, s68, 98304
    s_nop 0
    buffer_load_dwordx4 v2, s[28:31], s58 offen offset:0 lds
    buffer_load_dwordx4 v3, s[28:31], s58 offen offset:1024 lds
    buffer_load_dwordx4 v4, s[28:31], s58 offen offset:2048 lds
    buffer_load_dwordx4 v5, s[28:31], s58 offen offset:3072 lds
    s_add_u32 m0, s68, 114688
    s_nop 0
    buffer_load_dwordx4 v6, s[32:35], s59 offen offset:0 lds
    buffer_load_dwordx4 v7, s[32:35], s59 offen offset:1024 lds
    buffer_load_dwordx4 v8, s[32:35], s59 offen offset:2048 lds
    buffer_load_dwordx4 v9, s[32:35], s59 offen offset:3072 lds
    s_add_u32 m0, s68, 0
    s_add_u32 s58, s58, 128
    s_cmp_eq_u32 s58, 1280
    s_cselect_b32 s58, 0, s58
    buffer_load_dwordx4 v2, s[28:31], s58 offen offset:0 lds
    buffer_load_dwordx4 v3, s[28:31], s58 offen offset:1024 lds
    buffer_load_dwordx4 v4, s[28:31], s58 offen offset:2048 lds
    buffer_load_dwordx4 v5, s[28:31], s58 offen offset:3072 lds
    s_add_u32 m0, s68, 16384
    s_add_u32 s59, s59, 245760
    s_cmp_eq_u32 s59, 2457600
    s_cselect_b32 s59, 0, s59
    buffer_load_dwordx4 v6, s[32:35], s59 offen offset:0 lds
    buffer_load_dwordx4 v7, s[32:35], s59 offen offset:1024 lds
    buffer_load_dwordx4 v8, s[32:35], s59 offen offset:2048 lds
    buffer_load_dwordx4 v9, s[32:35], s59 offen offset:3072 lds
s1_nodma:
    s_mov_b32 s64, s12
    s_and_b32 s65, s13, 0xffff
    s_mov_b32 s66, 2211840
    s_mov_b32 s67, 0x20000
    s_mov_b32 s36, s26
    s_and_b32 s37, s27, 0xffff
    s_mov_b32 s38, 27262976
    s_mov_b32 s39, 0x20000
    v_mov_b32 v250, 0x7ffffff0
    v_cmp_eq_u32 s[52:53], 0, v0
    s_nop 1
    v_cndmask_b32 v250, v250, 0, s[52:53]
    s_or_b32 s48, s2, s44
    s_cmp_lg_u32 s48, 0
    s_cbranch_scc1 np_2
    s_memrealtime s[52:53]
    s_waitcnt lgkmcnt(0)
    s_or_b32 s52, s52, 1
    v_mov_b32 v248, s52
    v_mov_b32 v249, 0
    s_mov_b64 exec, 1
    global_store_dword v249, v248, s[24:25] sc1
    s_mov_b64 exec, -1
np_2:
    s_lshl_b32 s48, s46, 1
    s_and_b32 s49, s47, 1
    s_add_u32 s89, s48, s49
    s_lshr_b32 s88, s47, 1
    s_lshr_b32 s78, s44, 2
    s_and_b32 s79, s44, 3
    s_lshr_b32 s48, s46, 1
    s_lshl_b32 s48, s48, 3
    s_and_b32 s49, s47, 7
    s_add_u32 s73, s48, s49
    s_and_b32 s48, s46, 1
    s_lshl_b32 s48, s48, 2
    s_lshr_b32 s49, s47, 3
    s_add_u32 s74, s48, s49
    s_mul_i32 s75, s44, 5120
    s_mul_i32 s48, s74, 378880
    s_add_u32 s48, s48, s75
    s_add_u32 s76, s48, 22020096
    s_lshl_b32 s48, s56, 7
    s_lshl_b32 s49, s57, 2
    s_add_u32 s48, s48, s49
    s_add_u32 s69, s48, 25168896
    s_add_u32 s70, s48, 25170944
    s_cmp_lt_u32 s57, 14
    s_cselect_b32 s86, s70, 0x7fff0000
    s_cmp_lt_u32 s44, 4
    s_cbranch_scc1 s1_g0
    s_setprio 1
    s_mul_i32 s48, s47, 3
    s_lshl_b32 s49, s47, 1
    s_add_u32 s49, s49, 10
    s_cmp_lt_u32 s47, 10
    s_cselect_b32 s48, s48, s49
    s_cselect_b32 s49, 3, 2
    s_sub_u32 s50, s44, 4
    s_add_u32 s82, s48, s50
    s_cmp_lt_u32 s50, s49
    s_cselect_b32 s82, s82, 0x100
    s_cselect_b32 s83, 0, 0x7fff0000
    s_mul_i32 s50, s50, 5120
    s_add_u32 s50, s50, 147456
    s_cmp_lt_u32 s82, 74
    s_cselect_b32 s84, s50, 163840
    v_mov_b32 v128, 0
    v_mov_b32 v129, 0
    v_mov_b32 v130, 0
    v_mov_b32 v131, 0
    v_mov_b32 v132, 0
    s_mov_b32 s40, s16
    s_and_b32 s41, s17, 0xffff
    s_mov_b32 s42, 2211840
    s_mov_b32 s43, 0x20000
    s_cmp_ge_u32 s82, 74
    s_cbranch_scc1 s1_pa_go
    s_movk_i32 s54, 6554
    s_movk_i32 s55, 1280
    s_mul_i32 s50, s46, 160
    s_cmp_ge_u32 s82, 54
    s_cbranch_scc1 s1_pa_wo
    s_lshl_b32 s51, s82, 5
    v_add_u32 v176, 0, v1
    v_mul_u32_u24 v177, s54, v176
    v_lshrrev_b32 v177, 16, v177
    v_mul_u32_u24 v178, 10, v177
    v_sub_u32 v178, v176, v178
    v_add_u32 v177, s51, v177
    v_mul_lo_u32 v177, v177, s55
    v_lshl_add_u32 v177, v178, 4, v177
    v_add_u32 v128, s50, v177
    v_add_u32 v176, 64, v1
    v_mul_u32_u24 v177, s54, v176
    v_lshrrev_b32 v177, 16, v177
    v_mul_u32_u24 v178, 10, v177
    v_sub_u32 v178, v176, v178
    v_add_u32 v177, s51, v177
    v_mul_lo_u32 v177, v177, s55
    v_lshl_add_u32 v177, v178, 4, v177
    v_add_u32 v129, s50, v177
    v_add_u32 v176, 128, v1
    v_mul_u32_u24 v177, s54, v176
    v_lshrrev_b32 v177, 16, v177
    v_mul_u32_u24 v178, 10, v177
    v_sub_u32 v178, v176, v178
    v_add_u32 v177, s51, v177
    v_mul_lo_u32 v177, v177, s55
    v_lshl_add_u32 v177, v178, 4, v177
    v_add_u32 v130, s50, v177
    v_add_u32 v176, 192, v1
    v_mul_u32_u24 v177, s54, v176
    v_lshrrev_b32 v177, 16, v177
    v_mul_u32_u24 v178, 10, v177
    v_sub_u32 v178, v176, v178
    v_add_u32 v177, s51, v177
    v_mul_lo_u32 v177, v177, s55
    v_lshl_add_u32 v177, v178, 4, v177
    v_add_u32 v131, s50, v177
    v_add_u32 v176, 256, v1
    v_mul_u32_u24 v177, s54, v176
    v_lshrrev_b32 v177, 16, v177
    v_mul_u32_u24 v178, 10, v177
    v_sub_u32 v178, v176, v178
    v_add_u32 v177, s51, v177
    v_mul_lo_u32 v177, v177, s55
    v_lshl_add_u32 v177, v178, 4, v177
    v_add_u32 v132, s50, v177
    s_branch s1_pa_go
s1_pa_wo:
    s_mov_b32 s40, s8
    s_and_b32 s41, s9, 0xffff
    s_mov_b32 s42, 819200
    s_mov_b32 s43, 0x20000
    s_sub_u32 s51, s82, 54
    s_lshl_b32 s51, s51, 1
    v_add_u32 v176, 0, v1
    v_mul_u32_u24 v177, s54, v176
    v_lshrrev_b32 v177, 16, v177
    v_mul_u32_u24 v178, 10, v177
    v_sub_u32 v178, v176, v178
    v_lshrrev_b32 v179, 4, v177
    v_add_u32 v179, s51, v179
    v_and_b32 v177, 15, v177
    v_mul_u32_u24 v180, 20, v179
    v_add_u32 v180, v180, v177
    v_cmp_gt_u32 s[98:99], 32, v179
    v_subrev_u32 v179, 32, v179
    v_lshlrev_b32 v179, 2, v179
    v_bfe_u32 v181, v177, 2, 1
    v_lshl_add_u32 v179, v181, 1, v179
    v_lshrrev_b32 v181, 3, v177
    v_add_u32 v179, v179, v181
    v_mul_u32_u24 v179, 20, v179
    v_and_b32 v177, 3, v177
    v_add3_u32 v179, v179, v177, 16
    v_cndmask_b32 v177, v179, v180, s[98:99]
    v_mul_lo_u32 v177, v177, s55
    v_lshl_add_u32 v177, v178, 4, v177
    v_add_u32 v128, s50, v177
    v_add_u32 v176, 64, v1
    v_mul_u32_u24 v177, s54, v176
    v_lshrrev_b32 v177, 16, v177
    v_mul_u32_u24 v178, 10, v177
    v_sub_u32 v178, v176, v178
    v_lshrrev_b32 v179, 4, v177
    v_add_u32 v179, s51, v179
    v_and_b32 v177, 15, v177
    v_mul_u32_u24 v180, 20, v179
    v_add_u32 v180, v180, v177
    v_cmp_gt_u32 s[98:99], 32, v179
    v_subrev_u32 v179, 32, v179
    v_lshlrev_b32 v179, 2, v179
    v_bfe_u32 v181, v177, 2, 1
    v_lshl_add_u32 v179, v181, 1, v179
    v_lshrrev_b32 v181, 3, v177
    v_add_u32 v179, v179, v181
    v_mul_u32_u24 v179, 20, v179
    v_and_b32 v177, 3, v177
    v_add3_u32 v179, v179, v177, 16
    v_cndmask_b32 v177, v179, v180, s[98:99]
    v_mul_lo_u32 v177, v177, s55
    v_lshl_add_u32 v177, v178, 4, v177
    v_add_u32 v129, s50, v177
    v_add_u32 v176, 128, v1
    v_mul_u32_u24 v177, s54, v176
    v_lshrrev_b32 v177, 16, v177
    v_mul_u32_u24 v178, 10, v177
    v_sub_u32 v178, v176, v178
    v_lshrrev_b32 v179, 4, v177
    v_add_u32 v179, s51, v179
    v_and_b32 v177, 15, v177
    v_mul_u32_u24 v180, 20, v179
    v_add_u32 v180, v180, v177
    v_cmp_gt_u32 s[98:99], 32, v179
    v_subrev_u32 v179, 32, v179
    v_lshlrev_b32 v179, 2, v179
    v_bfe_u32 v181, v177, 2, 1
    v_lshl_add_u32 v179, v181, 1, v179
    v_lshrrev_b32 v181, 3, v177
    v_add_u32 v179, v179, v181
    v_mul_u32_u24 v179, 20, v179
    v_and_b32 v177, 3, v177
    v_add3_u32 v179, v179, v177, 16
    v_cndmask_b32 v177, v179, v180, s[98:99]
    v_mul_lo_u32 v177, v177, s55
    v_lshl_add_u32 v177, v178, 4, v177
    v_add_u32 v130, s50, v177
    v_add_u32 v176, 192, v1
    v_mul_u32_u24 v177, s54, v176
    v_lshrrev_b32 v177, 16, v177
    v_mul_u32_u24 v178, 10, v177
    v_sub_u32 v178, v176, v178
    v_lshrrev_b32 v179, 4, v177
    v_add_u32 v179, s51, v179
    v_and_b32 v177, 15, v177
    v_mul_u32_u24 v180, 20, v179
    v_add_u32 v180, v180, v177
    v_cmp_gt_u32 s[98:99], 32, v179
    v_subrev_u32 v179, 32, v179
    v_lshlrev_b32 v179, 2, v179
    v_bfe_u32 v181, v177, 2, 1
    v_lshl_add_u32 v179, v181, 1, v179
    v_lshrrev_b32 v181, 3, v177
    v_add_u32 v179, v179, v181
    v_mul_u32_u24 v179, 20, v179
    v_and_b32 v177, 3, v177
    v_add3_u32 v179, v179, v177, 16
    v_cndmask_b32 v177, v179, v180, s[98:99]
    v_mul_lo_u32 v177, v177, s55
    v_lshl_add_u32 v177, v178, 4, v177
    v_add_u32 v131, s50, v177
    v_add_u32 v176, 256, v1
    v_mul_u32_u24 v177, s54, v176
    v_lshrrev_b32 v177, 16, v177
    v_mul_u32_u24 v178, 10, v177
    v_sub_u32 v178, v176, v178
    v_lshrrev_b32 v179, 4, v177
    v_add_u32 v179, s51, v179
    v_and_b32 v177, 15, v177
    v_mul_u32_u24 v180, 20, v179
    v_add_u32 v180, v180, v177
    v_cmp_gt_u32 s[98:99], 32, v179
    v_subrev_u32 v179, 32, v179
    v_lshlrev_b32 v179, 2, v179
    v_bfe_u32 v181, v177, 2, 1
    v_lshl_add_u32 v179, v181, 1, v179
    v_lshrrev_b32 v181, 3, v177
    v_add_u32 v179, v179, v181
    v_mul_u32_u24 v179, 20, v179
    v_and_b32 v177, 3, v177
    v_add3_u32 v179, v179, v177, 16
    v_cndmask_b32 v177, v179, v180, s[98:99]
    v_mul_lo_u32 v177, v177, s55
    v_lshl_add_u32 v177, v178, 4, v177
    v_add_u32 v132, s50, v177
s1_pa_go:
    s_and_b32 s48, s90, 1
    s_lshl_b32 s48, s48, 13
    v_and_b32 v26, 31, v1
    v_lshrrev_b32 v27, 5, v1
    v_bfe_u32 v28, v1, 1, 3
    v_lshlrev_b32 v26, 7, v26
    v_add_u32 v26, s48, v26
    v_or_b32 v29, 0, v27
    v_xor_b32 v29, v29, v28
    v_lshl_add_u32 v14, v29, 4, v26
    v_add_u32 v18, 65536, v14
    v_or_b32 v29, 2, v27
    v_xor_b32 v29, v29, v28
    v_lshl_add_u32 v15, v29, 4, v26
    v_add_u32 v19, 65536, v15
    v_or_b32 v29, 4, v27
    v_xor_b32 v29, v29, v28
    v_lshl_add_u32 v16, v29, 4, v26
    v_add_u32 v20, 65536, v16
    v_or_b32 v29, 6, v27
    v_xor_b32 v29, v29, v28
    v_lshl_add_u32 v17, v29, 4, v26
    v_add_u32 v21, 65536, v17
    v_bfe_u32 v26, v1, 2, 2
    v_lshl_add_u32 v27, v27, 3, v26
    v_lshlrev_b32 v27, 8, v27
    v_bfe_u32 v28, v1, 4, 1
    v_lshl_add_u32 v27, v28, 5, v27
    v_and_b32 v28, 3, v1
    v_lshl_add_u32 v27, v28, 3, v27
    s_and_b32 s48, s90, 2
    s_or_b32 s49, s48, 0
    v_xor_b32 v28, s49, v26
    v_lshl_add_u32 v22, v28, 6, v27
    v_add_u32 v24, 65536, v22
    s_or_b32 s49, s48, 1
    v_xor_b32 v28, s49, v26
    v_lshl_add_u32 v23, v28, 6, v27
    v_add_u32 v25, 65536, v23
    s_waitcnt vmcnt(8)
    s_barrier
    s_add_u32 m0, s68, 32768
    s_add_u32 s58, s58, 128
    s_cmp_eq_u32 s58, 1280
    s_cselect_b32 s58, 0, s58
    buffer_load_dwordx4 v2, s[28:31], s58 offen offset:0 lds
    buffer_load_dwordx4 v3, s[28:31], s58 offen offset:1024 lds
    buffer_load_dwordx4 v4, s[28:31], s58 offen offset:2048 lds
    buffer_load_dwordx4 v5, s[28:31], s58 offen offset:3072 lds
    s_add_u32 m0, s68, 49152
    s_add_u32 s59, s59, 245760
    s_cmp_eq_u32 s59, 2457600
    s_cselect_b32 s59, 0, s59
    buffer_load_dwordx4 v6, s[32:35], s59 offen offset:0 lds
    buffer_load_dwordx4 v7, s[32:35], s59 offen offset:1024 lds
    buffer_load_dwordx4 v8, s[32:35], s59 offen offset:2048 lds
    buffer_load_dwordx4 v9, s[32:35], s59 offen offset:3072 lds
    s_add_u32 m0, s68, 65536
    s_add_u32 s58, s58, 128
    s_cmp_eq_u32 s58, 1280
    s_cselect_b32 s58, 0, s58
    buffer_load_dwordx4 v2, s[28:31], s58 offen offset:0 lds
    buffer_load_dwordx4 v3, s[28:31], s58 offen offset:1024 lds
    buffer_load_dwordx4 v4, s[28:31], s58 offen offset:2048 lds
    buffer_load_dwordx4 v5, s[28:31], s58 offen offset:3072 lds
    s_add_u32 m0, s68, 81920
    s_add_u32 s59, s59, 245760
    s_cmp_eq_u32 s59, 2457600
    s_cselect_b32 s59, 0, s59
    buffer_load_dwordx4 v6, s[32:35], s59 offen offset:0 lds
    buffer_load_dwordx4 v7, s[32:35], s59 offen offset:1024 lds
    buffer_load_dwordx4 v8, s[32:35], s59 offen offset:2048 lds
    buffer_load_dwordx4 v9, s[32:35], s59 offen offset:3072 lds
    s_waitcnt vmcnt(16)
    s_barrier
    s_add_u32 m0, s68, 98304
    s_add_u32 s58, s58, 128
    s_cmp_eq_u32 s58, 1280
    s_cselect_b32 s58, 0, s58
    buffer_load_dwordx4 v2, s[28:31], s58 offen offset:0 lds
    buffer_load_dwordx4 v3, s[28:31], s58 offen offset:1024 lds
    buffer_load_dwordx4 v4, s[28:31], s58 offen offset:2048 lds
    buffer_load_dwordx4 v5, s[28:31], s58 offen offset:3072 lds
    s_add_u32 m0, s68, 114688
    s_add_u32 s59, s59, 245760
    s_cmp_eq_u32 s59, 2457600
    s_cselect_b32 s59, 0, s59
    buffer_load_dwordx4 v6, s[32:35], s59 offen offset:0 lds
    buffer_load_dwordx4 v7, s[32:35], s59 offen offset:1024 lds
    buffer_load_dwordx4 v8, s[32:35], s59 offen offset:2048 lds
    buffer_load_dwordx4 v9, s[32:35], s59 offen offset:3072 lds
    s_add_u32 m0, s84, 0
    s_nop 0
    buffer_load_dwordx4 v128, s[40:43], s83 offen lds
    s_add_u32 m0, s84, 1024
    s_nop 0
    buffer_load_dwordx4 v129, s[40:43], s83 offen lds
    s_add_u32 m0, s84, 2048
    s_nop 0
    buffer_load_dwordx4 v130, s[40:43], s83 offen lds
    s_add_u32 m0, s84, 3072
    s_nop 0
    buffer_load_dwordx4 v131, s[40:43], s83 offen lds
    s_add_u32 m0, s84, 4096
    s_nop 0
    buffer_load_dwordx4 v132, s[40:43], s83 offen lds
    s_waitcnt vmcnt(21)
    s_barrier
    s_add_u32 m0, s68, 0
    s_add_u32 s58, s58, 128
    s_cmp_eq_u32 s58, 1280
    s_cselect_b32 s58, 0, s58
    buffer_load_dwordx4 v2, s[28:31], s58 offen offset:0 lds
    buffer_load_dwordx4 v3, s[28:31], s58 offen offset:1024 lds
    buffer_load_dwordx4 v4, s[28:31], s58 offen offset:2048 lds
    buffer_load_dwordx4 v5, s[28:31], s58 offen offset:3072 lds
    s_add_u32 m0, s68, 16384
    s_add_u32 s59, s59, 245760
    s_cmp_eq_u32 s59, 2457600
    s_cselect_b32 s59, 0, s59
    buffer_load_dwordx4 v6, s[32:35], s59 offen offset:0 lds
    buffer_load_dwordx4 v7, s[32:35], s59 offen offset:1024 lds
    buffer_load_dwordx4 v8, s[32:35], s59 offen offset:2048 lds
    buffer_load_dwordx4 v9, s[32:35], s59 offen offset:3072 lds
    s_waitcnt vmcnt(21)
    s_barrier
    s_add_u32 m0, s68, 32768
    s_add_u32 s58, s58, 128
    s_cmp_eq_u32 s58, 1280
    s_cselect_b32 s58, 0, s58
    buffer_load_dwordx4 v2, s[28:31], s58 offen offset:0 lds
    buffer_load_dwordx4 v3, s[28:31], s58 offen offset:1024 lds
    buffer_load_dwordx4 v4, s[28:31], s58 offen offset:2048 lds
    buffer_load_dwordx4 v5, s[28:31], s58 offen offset:3072 lds
    s_add_u32 m0, s68, 49152
    s_add_u32 s59, s59, 245760
    s_cmp_eq_u32 s59, 2457600
    s_cselect_b32 s59, 0, s59
    buffer_load_dwordx4 v6, s[32:35], s59 offen offset:0 lds
    buffer_load_dwordx4 v7, s[32:35], s59 offen offset:1024 lds
    buffer_load_dwordx4 v8, s[32:35], s59 offen offset:2048 lds
    buffer_load_dwordx4 v9, s[32:35], s59 offen offset:3072 lds
    s_waitcnt vmcnt(21)
    s_barrier
    s_add_u32 m0, s68, 65536
    s_add_u32 s58, s58, 128
    s_cmp_eq_u32 s58, 1280
    s_cselect_b32 s58, 0, s58
    buffer_load_dwordx4 v2, s[28:31], s58 offen offset:0 lds
    buffer_load_dwordx4 v3, s[28:31], s58 offen offset:1024 lds
    buffer_load_dwordx4 v4, s[28:31], s58 offen offset:2048 lds
    buffer_load_dwordx4 v5, s[28:31], s58 offen offset:3072 lds
    s_add_u32 m0, s68, 81920
    s_add_u32 s59, s59, 245760
    s_cmp_eq_u32 s59, 2457600
    s_cselect_b32 s59, 0, s59
    buffer_load_dwordx4 v6, s[32:35], s59 offen offset:0 lds
    buffer_load_dwordx4 v7, s[32:35], s59 offen offset:1024 lds
    buffer_load_dwordx4 v8, s[32:35], s59 offen offset:2048 lds
    buffer_load_dwordx4 v9, s[32:35], s59 offen offset:3072 lds
    s_waitcnt vmcnt(16)
    s_barrier
    s_add_u32 m0, s68, 98304
    s_add_u32 s58, s58, 128
    s_cmp_eq_u32 s58, 1280
    s_cselect_b32 s58, 0, s58
    buffer_load_dwordx4 v2, s[28:31], s58 offen offset:0 lds
    buffer_load_dwordx4 v3, s[28:31], s58 offen offset:1024 lds
    buffer_load_dwordx4 v4, s[28:31], s58 offen offset:2048 lds
    buffer_load_dwordx4 v5, s[28:31], s58 offen offset:3072 lds
    s_add_u32 m0, s68, 114688
    s_add_u32 s59, s59, 245760
    s_cmp_eq_u32 s59, 2457600
    s_cselect_b32 s59, 0, s59
    buffer_load_dwordx4 v6, s[32:35], s59 offen offset:0 lds
    buffer_load_dwordx4 v7, s[32:35], s59 offen offset:1024 lds
    buffer_load_dwordx4 v8, s[32:35], s59 offen offset:2048 lds
    buffer_load_dwordx4 v9, s[32:35], s59 offen offset:3072 lds
    s_waitcnt vmcnt(16)
    s_barrier
    s_add_u32 m0, s68, 0
    s_add_u32 s58, s58, 128
    s_cmp_eq_u32 s58, 1280
    s_cselect_b32 s58, 0, s58
    buffer_load_dwordx4 v2, s[28:31], s58 offen offset:0 lds
    buffer_load_dwordx4 v3, s[28:31], s58 offen offset:1024 lds
    buffer_load_dwordx4 v4, s[28:31], s58 offen offset:2048 lds
    buffer_load_dwordx4 v5, s[28:31], s58 offen offset:3072 lds
    s_add_u32 m0, s68, 16384
    s_add_u32 s59, s59, 245760
    s_cmp_eq_u32 s59, 2457600
    s_cselect_b32 s59, 0, s59
    buffer_load_dwordx4 v6, s[32:35], s59 offen offset:0 lds
    buffer_load_dwordx4 v7, s[32:35], s59 offen offset:1024 lds
    buffer_load_dwordx4 v8, s[32:35], s59 offen offset:2048 lds
    buffer_load_dwordx4 v9, s[32:35], s59 offen offset:3072 lds
    v_mov_b32 v135, 0x7ffffff0
    s_cmp_ge_u32 s82, 74
    s_cbranch_scc1 rf_3
    s_mul_i32 s48, s46, 378880
    s_mul_i32 s49, s82, 5120
    s_add_u32 s48, s48, s49
    s_add_u32 s48, s48, 22020096
    v_lshlrev_b32 v135, 4, v1
    v_add_u32 v135, s48, v135
    v_lshrrev_b32 v134, 5, v1
    v_bfe_u32 v136, v1, 4, 1
    v_lshlrev_b32 v134, 4, v134
    v_lshl_add_u32 v134, v136, 2, v134
    v_bfe_u32 v136, v1, 2, 2
    v_add_u32 v134, v134, v136
    v_mul_u32_u24 v134, 160, v134
    v_and_b32 v136, 3, v1
    v_lshl_add_u32 v134, v136, 3, v134
    v_add_u32 v134, s84, v134
    ds_read_b64_tr_b16 v[136:137], v134 offset:0
    ds_read_b64_tr_b16 v[138:139], v134 offset:1280
    ds_read_b64_tr_b16 v[140:141], v134 offset:32
    ds_read_b64_tr_b16 v[142:143], v134 offset:1312
    ds_read_b64_tr_b16 v[144:145], v134 offset:64
    ds_read_b64_tr_b16 v[146:147], v134 offset:1344
    ds_read_b64_tr_b16 v[148:149], v134 offset:96
    ds_read_b64_tr_b16 v[150:151], v134 offset:1376
    ds_read_b64_tr_b16 v[152:153], v134 offset:128
    ds_read_b64_tr_b16 v[154:155], v134 offset:1408
    s_waitcnt lgkmcnt(0)
rf_3:
    s_movk_i32 s49, 0
    buffer_store_dwordx4 v[136:139], v135, s[36:39], s49 offen sc1
    s_movk_i32 s49, 1024
    buffer_store_dwordx4 v[140:143], v135, s[36:39], s49 offen sc1
    s_movk_i32 s49, 2048
    buffer_store_dwordx4 v[144:147], v135, s[36:39], s49 offen sc1
    s_movk_i32 s49, 3072
    buffer_store_dwordx4 v[148:151], v135, s[36:39], s49 offen sc1
    s_movk_i32 s49, 4096
    buffer_store_dwordx4 v[152:155], v135, s[36:39], s49 offen sc1
    s_waitcnt vmcnt(21)
    s_barrier
    s_add_u32 m0, s68, 49152
    s_nop 0
    buffer_load_dwordx4 v10, s[64:67], s80 offen offset:0 lds
    buffer_load_dwordx4 v11, s[64:67], s80 offen offset:1024 lds
    buffer_load_dwordx4 v12, s[64:67], s80 offen offset:2048 lds
    buffer_load_dwordx4 v13, s[64:67], s80 offen offset:3072 lds
    s_waitcnt vmcnt(17)
    s_barrier
    s_add_u32 m0, s68, 81920
    s_add_u32 s80, s80, 221184
    s_cmp_eq_u32 s80, 2211840
    s_cselect_b32 s80, 0, s80
    buffer_load_dwordx4 v10, s[64:67], s80 offen offset:0 lds
    buffer_load_dwordx4 v11, s[64:67], s80 offen offset:1024 lds
    buffer_load_dwordx4 v12, s[64:67], s80 offen offset:2048 lds
    buffer_load_dwordx4 v13, s[64:67], s80 offen offset:3072 lds
    v_mov_b32 v253, 0
    global_load_dword v252, v253, s[24:25] sc1
    s_waitcnt vmcnt(14)
    s_waitcnt vmcnt(9)
    s_barrier
    s_add_u32 m0, s68, 114688
    s_add_u32 s80, s80, 221184
    s_cmp_eq_u32 s80, 2211840
    s_cselect_b32 s80, 0, s80
    buffer_load_dwordx4 v10, s[64:67], s80 offen offset:0 lds
    buffer_load_dwordx4 v11, s[64:67], s80 offen offset:1024 lds
    buffer_load_dwordx4 v12, s[64:67], s80 offen offset:2048 lds
    buffer_load_dwordx4 v13, s[64:67], s80 offen offset:3072 lds
    s_waitcnt vmcnt(4)
ng_4:
    v_readfirstlane_b32 s96, v252
    s_nop 0
    s_cmp_lg_u32 s96, 0
    s_cbranch_scc1 ng_4_ok
    s_sleep 2
    global_load_dword v252, v253, s[24:25] sc1
    s_waitcnt vmcnt(0)
    s_branch ng_4
ng_4_ok:
    s_barrier
    s_setprio 3
    ds_read_b128 v[32:35], v14 offset:32768
    ds_read_b64_tr_b16 v[40:41], v22 offset:49152
    ds_read_b64_tr_b16 v[42:43], v22 offset:50176
    ds_read_b128 v[36:39], v14 offset:36864
    ds_read_b64_tr_b16 v[44:45], v23 offset:49152
    ds_read_b64_tr_b16 v[46:47], v23 offset:50176
    ds_read_b128 v[48:51], v15 offset:32768
    ds_read_b64_tr_b16 v[56:57], v22 offset:53248
    s_waitcnt lgkmcnt(5)
    v_mfma_f32_32x32x16_bf16 v[64:79], v[40:43], v[32:35], 0
    ds_read_b64_tr_b16 v[58:59], v22 offset:54272
    ds_read_b128 v[52:55], v15 offset:36864
    ds_read_b64_tr_b16 v[60:61], v23 offset:53248
    s_waitcnt lgkmcnt(7)
    v_mfma_f32_32x32x16_bf16 v[96:111], v[40:43], v[36:39], 0
    ds_read_b64_tr_b16 v[62:63], v23 offset:54272
    s_waitcnt lgkmcnt(6)
    v_mfma_f32_32x32x16_bf16 v[80:95], v[44:47], v[32:35], 0
    v_mfma_f32_32x32x16_bf16 v[112:127], v[44:47], v[36:39], 0
    ds_read_b128 v[32:35], v16 offset:32768
    ds_read_b64_tr_b16 v[40:41], v22 offset:57344
    s_waitcnt lgkmcnt(5)
    v_mfma_f32_32x32x16_bf16 v[64:79], v[56:59], v[48:51], v[64:79]
    ds_read_b64_tr_b16 v[42:43], v22 offset:58368
    ds_read_b128 v[36:39], v16 offset:36864
    ds_read_b64_tr_b16 v[44:45], v23 offset:57344
    s_waitcnt lgkmcnt(7)
    v_mfma_f32_32x32x16_bf16 v[96:111], v[56:59], v[52:55], v[96:111]
    ds_read_b64_tr_b16 v[46:47], v23 offset:58368
    s_waitcnt lgkmcnt(6)
    v_mfma_f32_32x32x16_bf16 v[80:95], v[60:63], v[48:51], v[80:95]
    v_mfma_f32_32x32x16_bf16 v[112:127], v[60:63], v[52:55], v[112:127]
    ds_read_b128 v[48:51], v17 offset:32768
    ds_read_b64_tr_b16 v[56:57], v22 offset:61440
    s_waitcnt lgkmcnt(5)
    v_mfma_f32_32x32x16_bf16 v[64:79], v[40:43], v[32:35], v[64:79]
    ds_read_b64_tr_b16 v[58:59], v22 offset:62464
    ds_read_b128 v[52:55], v17 offset:36864
    ds_read_b64_tr_b16 v[60:61], v23 offset:61440
    s_waitcnt lgkmcnt(7)
    v_mfma_f32_32x32x16_bf16 v[96:111], v[40:43], v[36:39], v[96:111]
    ds_read_b64_tr_b16 v[62:63], v23 offset:62464
    s_waitcnt lgkmcnt(6)
    v_mfma_f32_32x32x16_bf16 v[80:95], v[44:47], v[32:35], v[80:95]
    v_mfma_f32_32x32x16_bf16 v[112:127], v[44:47], v[36:39], v[112:127]
    s_waitcnt lgkmcnt(0)
    s_barrier
    ds_read_b128 v[32:35], v18 offset:0
    ds_read_b64_tr_b16 v[40:41], v24 offset:16384
    v_mfma_f32_32x32x16_bf16 v[64:79], v[56:59], v[48:51], v[64:79]
    ds_read_b64_tr_b16 v[42:43], v24 offset:17408
    ds_read_b128 v[36:39], v18 offset:4096
    ds_read_b64_tr_b16 v[44:45], v25 offset:16384
    v_mfma_f32_32x32x16_bf16 v[96:111], v[56:59], v[52:55], v[96:111]
    ds_read_b64_tr_b16 v[46:47], v25 offset:17408
    v_mfma_f32_32x32x16_bf16 v[80:95], v[60:63], v[48:51], v[80:95]
    v_mfma_f32_32x32x16_bf16 v[112:127], v[60:63], v[52:55], v[112:127]
    ds_read_b128 v[48:51], v19 offset:0
    ds_read_b64_tr_b16 v[56:57], v24 offset:20480
    s_waitcnt lgkmcnt(5)
    v_mfma_f32_32x32x16_bf16 v[64:79], v[40:43], v[32:35], v[64:79]
    ds_read_b64_tr_b16 v[58:59], v24 offset:21504
    ds_read_b128 v[52:55], v19 offset:4096
    ds_read_b64_tr_b16 v[60:61], v25 offset:20480
    s_waitcnt lgkmcnt(7)
    v_mfma_f32_32x32x16_bf16 v[96:111], v[40:43], v[36:39], v[96:111]
    ds_read_b64_tr_b16 v[62:63], v25 offset:21504
    s_waitcnt lgkmcnt(6)
    v_mfma_f32_32x32x16_bf16 v[80:95], v[44:47], v[32:35], v[80:95]
    v_mfma_f32_32x32x16_bf16 v[112:127], v[44:47], v[36:39], v[112:127]
    ds_read_b128 v[32:35], v20 offset:0
    ds_read_b64_tr_b16 v[40:41], v24 offset:24576
    s_waitcnt lgkmcnt(5)
    v_mfma_f32_32x32x16_bf16 v[64:79], v[56:59], v[48:51], v[64:79]
    ds_read_b64_tr_b16 v[42:43], v24 offset:25600
    ds_read_b128 v[36:39], v20 offset:4096
    ds_read_b64_tr_b16 v[44:45], v25 offset:24576
    s_waitcnt lgkmcnt(7)
    v_mfma_f32_32x32x16_bf16 v[96:111], v[56:59], v[52:55], v[96:111]
    ds_read_b64_tr_b16 v[46:47], v25 offset:25600
    s_waitcnt lgkmcnt(6)
    v_mfma_f32_32x32x16_bf16 v[80:95], v[60:63], v[48:51], v[80:95]
    v_mfma_f32_32x32x16_bf16 v[112:127], v[60:63], v[52:55], v[112:127]
    ds_read_b128 v[48:51], v21 offset:0
    ds_read_b64_tr_b16 v[56:57], v24 offset:28672
    s_waitcnt lgkmcnt(5)
    v_mfma_f32_32x32x16_bf16 v[64:79], v[40:43], v[32:35], v[64:79]
    ds_read_b64_tr_b16 v[58:59], v24 offset:29696
    ds_read_b128 v[52:55], v21 offset:4096
    ds_read_b64_tr_b16 v[60:61], v25 offset:28672
    s_waitcnt lgkmcnt(7)
    v_mfma_f32_32x32x16_bf16 v[96:111], v[40:43], v[36:39], v[96:111]
    ds_read_b64_tr_b16 v[62:63], v25 offset:29696
    s_waitcnt lgkmcnt(6)
    v_mfma_f32_32x32x16_bf16 v[80:95], v[44:47], v[32:35], v[80:95]
    v_mfma_f32_32x32x16_bf16 v[112:127], v[44:47], v[36:39], v[112:127]
    s_waitcnt lgkmcnt(0)
    s_waitcnt vmcnt(0)
    s_barrier
    ds_read_b128 v[32:35], v18 offset:32768
    ds_read_b64_tr_b16 v[40:41], v24 offset:49152
    v_mfma_f32_32x32x16_bf16 v[64:79], v[56:59], v[48:51], v[64:79]
    ds_read_b64_tr_b16 v[42:43], v24 offset:50176
    ds_read_b128 v[36:39], v18 offset:36864
    ds_read_b64_tr_b16 v[44:45], v25 offset:49152
    v_mfma_f32_32x32x16_bf16 v[96:111], v[56:59], v[52:55], v[96:111]
    ds_read_b64_tr_b16 v[46:47], v25 offset:50176
    v_mfma_f32_32x32x16_bf16 v[80:95], v[60:63], v[48:51], v[80:95]
    v_mfma_f32_32x32x16_bf16 v[112:127], v[60:63], v[52:55], v[112:127]
    ds_read_b128 v[48:51], v19 offset:32768
    ds_read_b64_tr_b16 v[56:57], v24 offset:53248
    s_waitcnt lgkmcnt(5)
    v_mfma_f32_32x32x16_bf16 v[64:79], v[40:43], v[32:35], v[64:79]
    ds_read_b64_tr_b16 v[58:59], v24 offset:54272
    ds_read_b128 v[52:55], v19 offset:36864
    ds_read_b64_tr_b16 v[60:61], v25 offset:53248
    s_waitcnt lgkmcnt(7)
    v_mfma_f32_32x32x16_bf16 v[96:111], v[40:43], v[36:39], v[96:111]
    ds_read_b64_tr_b16 v[62:63], v25 offset:54272
    s_waitcnt lgkmcnt(6)
    v_mfma_f32_32x32x16_bf16 v[80:95], v[44:47], v[32:35], v[80:95]
    v_mfma_f32_32x32x16_bf16 v[112:127], v[44:47], v[36:39], v[112:127]
    ds_read_b128 v[32:35], v20 offset:32768
    ds_read_b64_tr_b16 v[40:41], v24 offset:57344
    s_waitcnt lgkmcnt(5)
    v_mfma_f32_32x32x16_bf16 v[64:79], v[56:59], v[48:51], v[64:79]
    ds_read_b64_tr_b16 v[42:43], v24 offset:58368
    ds_read_b128 v[36:39], v20 offset:36864
    ds_read_b64_tr_b16 v[44:45], v25 offset:57344
    s_waitcnt lgkmcnt(7)
    v_mfma_f32_32x32x16_bf16 v[96:111], v[56:59], v[52:55], v[96:111]
    ds_read_b64_tr_b16 v[46:47], v25 offset:58368
    s_waitcnt lgkmcnt(6)
    v_mfma_f32_32x32x16_bf16 v[80:95], v[60:63], v[48:51], v[80:95]
    v_mfma_f32_32x32x16_bf16 v[112:127], v[60:63], v[52:55], v[112:127]
    ds_read_b128 v[48:51], v21 offset:32768
    ds_read_b64_tr_b16 v[56:57], v24 offset:61440
    s_waitcnt lgkmcnt(5)
    v_mfma_f32_32x32x16_bf16 v[64:79], v[40:43], v[32:35], v[64:79]
    ds_read_b64_tr_b16 v[58:59], v24 offset:62464
    ds_read_b128 v[52:55], v21 offset:36864
    ds_read_b64_tr_b16 v[60:61], v25 offset:61440
    s_waitcnt lgkmcnt(7)
    v_mfma_f32_32x32x16_bf16 v[96:111], v[40:43], v[36:39], v[96:111]
    ds_read_b64_tr_b16 v[62:63], v25 offset:62464
    s_waitcnt lgkmcnt(6)
    v_mfma_f32_32x32x16_bf16 v[80:95], v[44:47], v[32:35], v[80:95]
    v_mfma_f32_32x32x16_bf16 v[112:127], v[44:47], v[36:39], v[112:127]
    s_waitcnt lgkmcnt(0)
    s_barrier
    ds_read_b128 v[32:35], v14 offset:0
    ds_read_b64_tr_b16 v[40:41], v22 offset:16384
    v_mfma_f32_32x32x16_bf16 v[64:79], v[56:59], v[48:51], v[64:79]
    ds_read_b64_tr_b16 v[42:43], v22 offset:17408
    ds_read_b128 v[36:39], v14 offset:4096
    ds_read_b64_tr_b16 v[44:45], v23 offset:16384
    v_mfma_f32_32x32x16_bf16 v[96:111], v[56:59], v[52:55], v[96:111]
    ds_read_b64_tr_b16 v[46:47], v23 offset:17408
    v_mfma_f32_32x32x16_bf16 v[80:95], v[60:63], v[48:51], v[80:95]
    v_mfma_f32_32x32x16_bf16 v[112:127], v[60:63], v[52:55], v[112:127]
    ds_read_b128 v[48:51], v15 offset:0
    ds_read_b64_tr_b16 v[56:57], v22 offset:20480
    s_waitcnt lgkmcnt(5)
    v_mfma_f32_32x32x16_bf16 v[64:79], v[40:43], v[32:35], v[64:79]
    ds_read_b64_tr_b16 v[58:59], v22 offset:21504
    ds_read_b128 v[52:55], v15 offset:4096
    ds_read_b64_tr_b16 v[60:61], v23 offset:20480
    s_waitcnt lgkmcnt(7)
    v_mfma_f32_32x32x16_bf16 v[96:111], v[40:43], v[36:39], v[96:111]
    ds_read_b64_tr_b16 v[62:63], v23 offset:21504
    s_waitcnt lgkmcnt(6)
    v_mfma_f32_32x32x16_bf16 v[80:95], v[44:47], v[32:35], v[80:95]
    v_mfma_f32_32x32x16_bf16 v[112:127], v[44:47], v[36:39], v[112:127]
    ds_read_b128 v[32:35], v16 offset:0
    ds_read_b64_tr_b16 v[40:41], v22 offset:24576
    s_waitcnt lgkmcnt(5)
    v_mfma_f32_32x32x16_bf16 v[64:79], v[56:59], v[48:51], v[64:79]
    ds_read_b64_tr_b16 v[42:43], v22 offset:25600
    ds_read_b128 v[36:39], v16 offset:4096
    ds_read_b64_tr_b16 v[44:45], v23 offset:24576
    s_waitcnt lgkmcnt(7)
    v_mfma_f32_32x32x16_bf16 v[96:111], v[56:59], v[52:55], v[96:111]
    ds_read_b64_tr_b16 v[46:47], v23 offset:25600
    s_waitcnt lgkmcnt(6)
    v_mfma_f32_32x32x16_bf16 v[80:95], v[60:63], v[48:51], v[80:95]
    v_mfma_f32_32x32x16_bf16 v[112:127], v[60:63], v[52:55], v[112:127]
    ds_read_b128 v[48:51], v17 offset:0
    ds_read_b64_tr_b16 v[56:57], v22 offset:28672
    s_waitcnt lgkmcnt(5)
    v_mfma_f32_32x32x16_bf16 v[64:79], v[40:43], v[32:35], v[64:79]
    ds_read_b64_tr_b16 v[58:59], v22 offset:29696
    ds_read_b128 v[52:55], v17 offset:4096
    ds_read_b64_tr_b16 v[60:61], v23 offset:28672
    s_waitcnt lgkmcnt(7)
    v_mfma_f32_32x32x16_bf16 v[96:111], v[40:43], v[36:39], v[96:111]
    ds_read_b64_tr_b16 v[62:63], v23 offset:29696
    s_waitcnt lgkmcnt(6)
    v_mfma_f32_32x32x16_bf16 v[80:95], v[44:47], v[32:35], v[80:95]
    v_mfma_f32_32x32x16_bf16 v[112:127], v[44:47], v[36:39], v[112:127]
    s_waitcnt lgkmcnt(0)
    s_barrier
    ds_read_b128 v[32:35], v14 offset:32768
    ds_read_b64_tr_b16 v[40:41], v22 offset:49152
    v_mfma_f32_32x32x16_bf16 v[64:79], v[56:59], v[48:51], v[64:79]
    ds_read_b64_tr_b16 v[42:43], v22 offset:50176
    ds_read_b128 v[36:39], v14 offset:36864
    ds_read_b64_tr_b16 v[44:45], v23 offset:49152
    v_mfma_f32_32x32x16_bf16 v[96:111], v[56:59], v[52:55], v[96:111]
    ds_read_b64_tr_b16 v[46:47], v23 offset:50176
    v_mfma_f32_32x32x16_bf16 v[80:95], v[60:63], v[48:51], v[80:95]
    v_mfma_f32_32x32x16_bf16 v[112:127], v[60:63], v[52:55], v[112:127]
    ds_read_b128 v[48:51], v15 offset:32768
    ds_read_b64_tr_b16 v[56:57], v22 offset:53248
    s_waitcnt lgkmcnt(5)
    v_mfma_f32_32x32x16_bf16 v[64:79], v[40:43], v[32:35], v[64:79]
    ds_read_b64_tr_b16 v[58:59], v22 offset:54272
    ds_read_b128 v[52:55], v15 offset:36864
    ds_read_b64_tr_b16 v[60:61], v23 offset:53248
    s_waitcnt lgkmcnt(7)
    v_mfma_f32_32x32x16_bf16 v[96:111], v[40:43], v[36:39], v[96:111]
    ds_read_b64_tr_b16 v[62:63], v23 offset:54272
    s_waitcnt lgkmcnt(6)
    v_mfma_f32_32x32x16_bf16 v[80:95], v[44:47], v[32:35], v[80:95]
    v_mfma_f32_32x32x16_bf16 v[112:127], v[44:47], v[36:39], v[112:127]
    ds_read_b128 v[32:35], v16 offset:32768
    ds_read_b64_tr_b16 v[40:41], v22 offset:57344
    s_waitcnt lgkmcnt(5)
    v_mfma_f32_32x32x16_bf16 v[64:79], v[56:59], v[48:51], v[64:79]
    ds_read_b64_tr_b16 v[42:43], v22 offset:58368
    ds_read_b128 v[36:39], v16 offset:36864
    ds_read_b64_tr_b16 v[44:45], v23 offset:57344
    s_waitcnt lgkmcnt(7)
    v_mfma_f32_32x32x16_bf16 v[96:111], v[56:59], v[52:55], v[96:111]
    ds_read_b64_tr_b16 v[46:47], v23 offset:58368
    s_waitcnt lgkmcnt(6)
    v_mfma_f32_32x32x16_bf16 v[80:95], v[60:63], v[48:51], v[80:95]
    v_mfma_f32_32x32x16_bf16 v[112:127], v[60:63], v[52:55], v[112:127]
    ds_read_b128 v[48:51], v17 offset:32768
    ds_read_b64_tr_b16 v[56:57], v22 offset:61440
    s_waitcnt lgkmcnt(5)
    v_mfma_f32_32x32x16_bf16 v[64:79], v[40:43], v[32:35], v[64:79]
    ds_read_b64_tr_b16 v[58:59], v22 offset:62464
    ds_read_b128 v[52:55], v17 offset:36864
    ds_read_b64_tr_b16 v[60:61], v23 offset:61440
    s_waitcnt lgkmcnt(7)
    v_mfma_f32_32x32x16_bf16 v[96:111], v[40:43], v[36:39], v[96:111]
    ds_read_b64_tr_b16 v[62:63], v23 offset:62464
    s_waitcnt lgkmcnt(6)
    v_mfma_f32_32x32x16_bf16 v[80:95], v[44:47], v[32:35], v[80:95]
    v_mfma_f32_32x32x16_bf16 v[112:127], v[44:47], v[36:39], v[112:127]
    s_waitcnt lgkmcnt(0)
    s_barrier
    ds_read_b128 v[32:35], v18 offset:0
    ds_read_b64_tr_b16 v[40:41], v24 offset:16384
    v_mfma_f32_32x32x16_bf16 v[64:79], v[56:59], v[48:51], v[64:79]
    ds_read_b64_tr_b16 v[42:43], v24 offset:17408
    ds_read_b128 v[36:39], v18 offset:4096
    ds_read_b64_tr_b16 v[44:45], v25 offset:16384
    v_mfma_f32_32x32x16_bf16 v[96:111], v[56:59], v[52:55], v[96:111]
    ds_read_b64_tr_b16 v[46:47], v25 offset:17408
    v_mfma_f32_32x32x16_bf16 v[80:95], v[60:63], v[48:51], v[80:95]
    v_mfma_f32_32x32x16_bf16 v[112:127], v[60:63], v[52:55], v[112:127]
    ds_read_b128 v[48:51], v19 offset:0
    ds_read_b64_tr_b16 v[56:57], v24 offset:20480
    s_waitcnt lgkmcnt(5)
    v_mfma_f32_32x32x16_bf16 v[64:79], v[40:43], v[32:35], v[64:79]
    ds_read_b64_tr_b16 v[58:59], v24 offset:21504
    ds_read_b128 v[52:55], v19 offset:4096
    ds_read_b64_tr_b16 v[60:61], v25 offset:20480
    s_waitcnt lgkmcnt(7)
    v_mfma_f32_32x32x16_bf16 v[96:111], v[40:43], v[36:39], v[96:111]
    ds_read_b64_tr_b16 v[62:63], v25 offset:21504
    s_waitcnt lgkmcnt(6)
    v_mfma_f32_32x32x16_bf16 v[80:95], v[44:47], v[32:35], v[80:95]
    v_mfma_f32_32x32x16_bf16 v[112:127], v[44:47], v[36:39], v[112:127]
    ds_read_b128 v[32:35], v20 offset:0
    ds_read_b64_tr_b16 v[40:41], v24 offset:24576
    s_waitcnt lgkmcnt(5)
    v_mfma_f32_32x32x16_bf16 v[64:79], v[56:59], v[48:51], v[64:79]
    ds_read_b64_tr_b16 v[42:43], v24 offset:25600
    ds_read_b128 v[36:39], v20 offset:4096
    ds_read_b64_tr_b16 v[44:45], v25 offset:24576
    s_waitcnt lgkmcnt(7)
    v_mfma_f32_32x32x16_bf16 v[96:111], v[56:59], v[52:55], v[96:111]
    ds_read_b64_tr_b16 v[46:47], v25 offset:25600
    s_waitcnt lgkmcnt(6)
    v_mfma_f32_32x32x16_bf16 v[80:95], v[60:63], v[48:51], v[80:95]
    v_mfma_f32_32x32x16_bf16 v[112:127], v[60:63], v[52:55], v[112:127]
    ds_read_b128 v[48:51], v21 offset:0
    ds_read_b64_tr_b16 v[56:57], v24 offset:28672
    s_waitcnt lgkmcnt(5)
    v_mfma_f32_32x32x16_bf16 v[64:79], v[40:43], v[32:35], v[64:79]
    ds_read_b64_tr_b16 v[58:59], v24 offset:29696
    ds_read_b128 v[52:55], v21 offset:4096
    ds_read_b64_tr_b16 v[60:61], v25 offset:28672
    s_waitcnt lgkmcnt(7)
    v_mfma_f32_32x32x16_bf16 v[96:111], v[40:43], v[36:39], v[96:111]
    ds_read_b64_tr_b16 v[62:63], v25 offset:29696
    s_waitcnt lgkmcnt(6)
    v_mfma_f32_32x32x16_bf16 v[80:95], v[44:47], v[32:35], v[80:95]
    v_mfma_f32_32x32x16_bf16 v[112:127], v[44:47], v[36:39], v[112:127]
    s_waitcnt lgkmcnt(0)
    s_barrier
    ds_read_b128 v[32:35], v18 offset:32768
    ds_read_b64_tr_b16 v[40:41], v24 offset:49152
    v_mfma_f32_32x32x16_bf16 v[64:79], v[56:59], v[48:51], v[64:79]
    ds_read_b64_tr_b16 v[42:43], v24 offset:50176
    ds_read_b128 v[36:39], v18 offset:36864
    ds_read_b64_tr_b16 v[44:45], v25 offset:49152
    v_mfma_f32_32x32x16_bf16 v[96:111], v[56:59], v[52:55], v[96:111]
    ds_read_b64_tr_b16 v[46:47], v25 offset:50176
    v_mfma_f32_32x32x16_bf16 v[80:95], v[60:63], v[48:51], v[80:95]
    v_mfma_f32_32x32x16_bf16 v[112:127], v[60:63], v[52:55], v[112:127]
    ds_read_b128 v[48:51], v19 offset:32768
    ds_read_b64_tr_b16 v[56:57], v24 offset:53248
    s_waitcnt lgkmcnt(5)
    v_mfma_f32_32x32x16_bf16 v[64:79], v[40:43], v[32:35], v[64:79]
    ds_read_b64_tr_b16 v[58:59], v24 offset:54272
    ds_read_b128 v[52:55], v19 offset:36864
    ds_read_b64_tr_b16 v[60:61], v25 offset:53248
    s_waitcnt lgkmcnt(7)
    v_mfma_f32_32x32x16_bf16 v[96:111], v[40:43], v[36:39], v[96:111]
    ds_read_b64_tr_b16 v[62:63], v25 offset:54272
    s_waitcnt lgkmcnt(6)
    v_mfma_f32_32x32x16_bf16 v[80:95], v[44:47], v[32:35], v[80:95]
    v_mfma_f32_32x32x16_bf16 v[112:127], v[44:47], v[36:39], v[112:127]
    ds_read_b128 v[32:35], v20 offset:32768
    ds_read_b64_tr_b16 v[40:41], v24 offset:57344
    s_waitcnt lgkmcnt(5)
    v_mfma_f32_32x32x16_bf16 v[64:79], v[56:59], v[48:51], v[64:79]
    ds_read_b64_tr_b16 v[42:43], v24 offset:58368
    ds_read_b128 v[36:39], v20 offset:36864
    ds_read_b64_tr_b16 v[44:45], v25 offset:57344
    s_waitcnt lgkmcnt(7)
    v_mfma_f32_32x32x16_bf16 v[96:111], v[56:59], v[52:55], v[96:111]
    ds_read_b64_tr_b16 v[46:47], v25 offset:58368
    s_waitcnt lgkmcnt(6)
    v_mfma_f32_32x32x16_bf16 v[80:95], v[60:63], v[48:51], v[80:95]
    v_mfma_f32_32x32x16_bf16 v[112:127], v[60:63], v[52:55], v[112:127]
    ds_read_b128 v[48:51], v21 offset:32768
    ds_read_b64_tr_b16 v[56:57], v24 offset:61440
    s_waitcnt lgkmcnt(5)
    v_mfma_f32_32x32x16_bf16 v[64:79], v[40:43], v[32:35], v[64:79]
    ds_read_b64_tr_b16 v[58:59], v24 offset:62464
    ds_read_b128 v[52:55], v21 offset:36864
    ds_read_b64_tr_b16 v[60:61], v25 offset:61440
    s_waitcnt lgkmcnt(7)
    v_mfma_f32_32x32x16_bf16 v[96:111], v[40:43], v[36:39], v[96:111]
    ds_read_b64_tr_b16 v[62:63], v25 offset:62464
    s_waitcnt lgkmcnt(6)
    v_mfma_f32_32x32x16_bf16 v[80:95], v[44:47], v[32:35], v[80:95]
    v_mfma_f32_32x32x16_bf16 v[112:127], v[44:47], v[36:39], v[112:127]
    s_waitcnt lgkmcnt(0)
    s_barrier
    ds_read_b128 v[32:35], v14 offset:0
    ds_read_b64_tr_b16 v[40:41], v22 offset:16384
    v_mfma_f32_32x32x16_bf16 v[64:79], v[56:59], v[48:51], v[64:79]
    ds_read_b64_tr_b16 v[42:43], v22 offset:17408
    ds_read_b128 v[36:39], v14 offset:4096
    ds_read_b64_tr_b16 v[44:45], v23 offset:16384
    v_mfma_f32_32x32x16_bf16 v[96:111], v[56:59], v[52:55], v[96:111]
    ds_read_b64_tr_b16 v[46:47], v23 offset:17408
    v_mfma_f32_32x32x16_bf16 v[80:95], v[60:63], v[48:51], v[80:95]
    v_mfma_f32_32x32x16_bf16 v[112:127], v[60:63], v[52:55], v[112:127]
    ds_read_b128 v[48:51], v15 offset:0
    ds_read_b64_tr_b16 v[56:57], v22 offset:20480
    s_waitcnt lgkmcnt(5)
    v_mfma_f32_32x32x16_bf16 v[64:79], v[40:43], v[32:35], v[64:79]
    ds_read_b64_tr_b16 v[58:59], v22 offset:21504
    ds_read_b128 v[52:55], v15 offset:4096
    ds_read_b64_tr_b16 v[60:61], v23 offset:20480
    s_waitcnt lgkmcnt(7)
    v_mfma_f32_32x32x16_bf16 v[96:111], v[40:43], v[36:39], v[96:111]
    ds_read_b64_tr_b16 v[62:63], v23 offset:21504
    s_waitcnt lgkmcnt(6)
    v_mfma_f32_32x32x16_bf16 v[80:95], v[44:47], v[32:35], v[80:95]
    v_mfma_f32_32x32x16_bf16 v[112:127], v[44:47], v[36:39], v[112:127]
    ds_read_b128 v[32:35], v16 offset:0
    ds_read_b64_tr_b16 v[40:41], v22 offset:24576
    s_waitcnt lgkmcnt(5)
    v_mfma_f32_32x32x16_bf16 v[64:79], v[56:59], v[48:51], v[64:79]
    ds_read_b64_tr_b16 v[42:43], v22 offset:25600
    ds_read_b128 v[36:39], v16 offset:4096
    ds_read_b64_tr_b16 v[44:45], v23 offset:24576
    s_waitcnt lgkmcnt(7)
    v_mfma_f32_32x32x16_bf16 v[96:111], v[56:59], v[52:55], v[96:111]
    ds_read_b64_tr_b16 v[46:47], v23 offset:25600
    s_waitcnt lgkmcnt(6)
    v_mfma_f32_32x32x16_bf16 v[80:95], v[60:63], v[48:51], v[80:95]
    v_mfma_f32_32x32x16_bf16 v[112:127], v[60:63], v[52:55], v[112:127]
    ds_read_b128 v[48:51], v17 offset:0
    ds_read_b64_tr_b16 v[56:57], v22 offset:28672
    s_waitcnt lgkmcnt(5)
    v_mfma_f32_32x32x16_bf16 v[64:79], v[40:43], v[32:35], v[64:79]
    ds_read_b64_tr_b16 v[58:59], v22 offset:29696
    ds_read_b128 v[52:55], v17 offset:4096
    ds_read_b64_tr_b16 v[60:61], v23 offset:28672
    s_waitcnt lgkmcnt(7)
    v_mfma_f32_32x32x16_bf16 v[96:111], v[40:43], v[36:39], v[96:111]
    ds_read_b64_tr_b16 v[62:63], v23 offset:29696
    s_waitcnt lgkmcnt(6)
    v_mfma_f32_32x32x16_bf16 v[80:95], v[44:47], v[32:35], v[80:95]
    v_mfma_f32_32x32x16_bf16 v[112:127], v[44:47], v[36:39], v[112:127]
    s_waitcnt lgkmcnt(0)
    s_barrier
    ds_read_b128 v[32:35], v14 offset:32768
    ds_read_b64_tr_b16 v[40:41], v22 offset:49152
    v_mfma_f32_32x32x16_bf16 v[64:79], v[56:59], v[48:51], v[64:79]
    ds_read_b64_tr_b16 v[42:43], v22 offset:50176
    ds_read_b128 v[36:39], v14 offset:36864
    ds_read_b64_tr_b16 v[44:45], v23 offset:49152
    v_mfma_f32_32x32x16_bf16 v[96:111], v[56:59], v[52:55], v[96:111]
    ds_read_b64_tr_b16 v[46:47], v23 offset:50176
    v_mfma_f32_32x32x16_bf16 v[80:95], v[60:63], v[48:51], v[80:95]
    v_mfma_f32_32x32x16_bf16 v[112:127], v[60:63], v[52:55], v[112:127]
    ds_read_b128 v[48:51], v15 offset:32768
    ds_read_b64_tr_b16 v[56:57], v22 offset:53248
    s_waitcnt lgkmcnt(5)
    v_mfma_f32_32x32x16_bf16 v[64:79], v[40:43], v[32:35], v[64:79]
    ds_read_b64_tr_b16 v[58:59], v22 offset:54272
    ds_read_b128 v[52:55], v15 offset:36864
    ds_read_b64_tr_b16 v[60:61], v23 offset:53248
    s_waitcnt lgkmcnt(7)
    v_mfma_f32_32x32x16_bf16 v[96:111], v[40:43], v[36:39], v[96:111]
    ds_read_b64_tr_b16 v[62:63], v23 offset:54272
    s_waitcnt lgkmcnt(6)
    v_mfma_f32_32x32x16_bf16 v[80:95], v[44:47], v[32:35], v[80:95]
    v_mfma_f32_32x32x16_bf16 v[112:127], v[44:47], v[36:39], v[112:127]
    ds_read_b128 v[32:35], v16 offset:32768
    ds_read_b64_tr_b16 v[40:41], v22 offset:57344
    s_waitcnt lgkmcnt(5)
    v_mfma_f32_32x32x16_bf16 v[64:79], v[56:59], v[48:51], v[64:79]
    ds_read_b64_tr_b16 v[42:43], v22 offset:58368
    ds_read_b128 v[36:39], v16 offset:36864
    ds_read_b64_tr_b16 v[44:45], v23 offset:57344
    s_waitcnt lgkmcnt(7)
    v_mfma_f32_32x32x16_bf16 v[96:111], v[56:59], v[52:55], v[96:111]
    ds_read_b64_tr_b16 v[46:47], v23 offset:58368
    s_waitcnt lgkmcnt(6)
    v_mfma_f32_32x32x16_bf16 v[80:95], v[60:63], v[48:51], v[80:95]
    v_mfma_f32_32x32x16_bf16 v[112:127], v[60:63], v[52:55], v[112:127]
    ds_read_b128 v[48:51], v17 offset:32768
    ds_read_b64_tr_b16 v[56:57], v22 offset:61440
    s_waitcnt lgkmcnt(5)
    v_mfma_f32_32x32x16_bf16 v[64:79], v[40:43], v[32:35], v[64:79]
    ds_read_b64_tr_b16 v[58:59], v22 offset:62464
    ds_read_b128 v[52:55], v17 offset:36864
    ds_read_b64_tr_b16 v[60:61], v23 offset:61440
    s_waitcnt lgkmcnt(7)
    v_mfma_f32_32x32x16_bf16 v[96:111], v[40:43], v[36:39], v[96:111]
    ds_read_b64_tr_b16 v[62:63], v23 offset:62464
    s_waitcnt lgkmcnt(6)
    v_mfma_f32_32x32x16_bf16 v[80:95], v[44:47], v[32:35], v[80:95]
    v_mfma_f32_32x32x16_bf16 v[112:127], v[44:47], v[36:39], v[112:127]
    s_waitcnt lgkmcnt(0)
    s_barrier
    ds_read_b128 v[32:35], v18 offset:0
    ds_read_b64_tr_b16 v[40:41], v24 offset:16384
    v_mfma_f32_32x32x16_bf16 v[64:79], v[56:59], v[48:51], v[64:79]
    ds_read_b64_tr_b16 v[42:43], v24 offset:17408
    ds_read_b128 v[36:39], v18 offset:4096
    ds_read_b64_tr_b16 v[44:45], v25 offset:16384
    v_mfma_f32_32x32x16_bf16 v[96:111], v[56:59], v[52:55], v[96:111]
    ds_read_b64_tr_b16 v[46:47], v25 offset:17408
    v_mfma_f32_32x32x16_bf16 v[80:95], v[60:63], v[48:51], v[80:95]
    v_mfma_f32_32x32x16_bf16 v[112:127], v[60:63], v[52:55], v[112:127]
    ds_read_b128 v[48:51], v19 offset:0
    ds_read_b64_tr_b16 v[56:57], v24 offset:20480
    s_waitcnt lgkmcnt(5)
    v_mfma_f32_32x32x16_bf16 v[64:79], v[40:43], v[32:35], v[64:79]
    ds_read_b64_tr_b16 v[58:59], v24 offset:21504
    ds_read_b128 v[52:55], v19 offset:4096
    ds_read_b64_tr_b16 v[60:61], v25 offset:20480
    s_waitcnt lgkmcnt(7)
    v_mfma_f32_32x32x16_bf16 v[96:111], v[40:43], v[36:39], v[96:111]
    ds_read_b64_tr_b16 v[62:63], v25 offset:21504
    s_waitcnt lgkmcnt(6)
    v_mfma_f32_32x32x16_bf16 v[80:95], v[44:47], v[32:35], v[80:95]
    v_mfma_f32_32x32x16_bf16 v[112:127], v[44:47], v[36:39], v[112:127]
    ds_read_b128 v[32:35], v20 offset:0
    ds_read_b64_tr_b16 v[40:41], v24 offset:24576
    s_waitcnt lgkmcnt(5)
    v_mfma_f32_32x32x16_bf16 v[64:79], v[56:59], v[48:51], v[64:79]
    ds_read_b64_tr_b16 v[42:43], v24 offset:25600
    ds_read_b128 v[36:39], v20 offset:4096
    ds_read_b64_tr_b16 v[44:45], v25 offset:24576
    s_waitcnt lgkmcnt(7)
    v_mfma_f32_32x32x16_bf16 v[96:111], v[56:59], v[52:55], v[96:111]
    ds_read_b64_tr_b16 v[46:47], v25 offset:25600
    s_waitcnt lgkmcnt(6)
    v_mfma_f32_32x32x16_bf16 v[80:95], v[60:63], v[48:51], v[80:95]
    v_mfma_f32_32x32x16_bf16 v[112:127], v[60:63], v[52:55], v[112:127]
    ds_read_b128 v[48:51], v21 offset:0
    ds_read_b64_tr_b16 v[56:57], v24 offset:28672
    s_waitcnt lgkmcnt(5)
    v_mfma_f32_32x32x16_bf16 v[64:79], v[40:43], v[32:35], v[64:79]
    ds_read_b64_tr_b16 v[58:59], v24 offset:29696
    ds_read_b128 v[52:55], v21 offset:4096
    ds_read_b64_tr_b16 v[60:61], v25 offset:28672
    s_waitcnt lgkmcnt(7)
    v_mfma_f32_32x32x16_bf16 v[96:111], v[40:43], v[36:39], v[96:111]
    ds_read_b64_tr_b16 v[62:63], v25 offset:29696
    s_waitcnt lgkmcnt(6)
    v_mfma_f32_32x32x16_bf16 v[80:95], v[44:47], v[32:35], v[80:95]
    v_mfma_f32_32x32x16_bf16 v[112:127], v[44:47], v[36:39], v[112:127]
    s_waitcnt lgkmcnt(0)
    s_barrier
    v_mfma_f32_32x32x16_bf16 v[64:79], v[56:59], v[48:51], v[64:79]
    v_mfma_f32_32x32x16_bf16 v[96:111], v[56:59], v[52:55], v[96:111]
    v_mfma_f32_32x32x16_bf16 v[80:95], v[60:63], v[48:51], v[80:95]
    v_mfma_f32_32x32x16_bf16 v[112:127], v[60:63], v[52:55], v[112:127]
    v_mov_b32 v6, 1.0
    v_mov_b32 v2, 0xc0135761
    v_mov_b32 v3, 0xbdd2d3e8
    v_lshlrev_b32 v4, 4, v1
    s_lshl_b32 s48, s57, 3
    s_lshr_b32 s49, s90, 1
    s_lshl_b32 s49, s49, 2
    s_add_u32 s71, s48, s49
    s_lshl_b32 s48, s56, 2
    s_and_b32 s49, s90, 1
    s_lshl_b32 s49, s49, 1
    s_add_u32 s48, s48, s49
    s_mul_i32 s48, s48, 108
    s_add_u32 s48, s48, s71
    s_lshl_b32 s48, s48, 10
    s_add_u32 s72, s48, 11534336
    s_cmp_lt_u32 s71, 108
    s_cselect_b32 s72, s72, 0x7fff0000
    v_and_b32 v26, 31, v1
    v_lshlrev_b32 v26, 4, v26
    s_and_b32 s48, s90, 1
    s_lshl_b32 s48, s48, 9
    v_add_u32 v26, s48, v26
    ds_read_b128 v[192:195], v26
    v_lshrrev_b32 v26, 5, v1
    v_lshlrev_b32 v26, 4, v26
    s_lshr_b32 s48, s90, 1
    s_lshl_b32 s48, s48, 8
    v_add_u32 v26, s48, v26
    ds_read_b128 v[128:131], v26 offset:1024
    ds_read_b128 v[160:163], v26 offset:1536
    ds_read_b128 v[132:135], v26 offset:1056
    ds_read_b128 v[164:167], v26 offset:1568
    ds_read_b128 v[136:139], v26 offset:1088
    ds_read_b128 v[168:171], v26 offset:1600
    ds_read_b128 v[140:143], v26 offset:1120
    ds_read_b128 v[172:175], v26 offset:1632
    ds_read_b128 v[144:147], v26 offset:1152
    ds_read_b128 v[176:179], v26 offset:1664
    ds_read_b128 v[148:151], v26 offset:1184
    ds_read_b128 v[180:183], v26 offset:1696
    ds_read_b128 v[152:155], v26 offset:1216
    ds_read_b128 v[184:187], v26 offset:1728
    ds_read_b128 v[156:159], v26 offset:1248
    ds_read_b128 v[188:191], v26 offset:1760
    s_waitcnt lgkmcnt(0)
    v_pk_fma_f32 v[32:33], v[192:193], v[128:129], v[160:161] op_sel_hi:[0,1,1]
    v_pk_fma_f32 v[34:35], v[192:193], v[130:131], v[162:163] op_sel_hi:[0,1,1]
    v_pk_fma_f32 v[36:37], v[192:193], v[132:133], v[164:165] op_sel_hi:[0,1,1]
    v_pk_fma_f32 v[38:39], v[192:193], v[134:135], v[166:167] op_sel_hi:[0,1,1]
    v_pk_fma_f32 v[64:65], v[192:193], v[64:65], v[32:33] op_sel:[1,0,0] op_sel_hi:[1,1,1]
    v_pk_fma_f32 v[66:67], v[192:193], v[66:67], v[34:35] op_sel:[1,0,0] op_sel_hi:[1,1,1]
    v_pk_fma_f32 v[68:69], v[192:193], v[68:69], v[36:37] op_sel:[1,0,0] op_sel_hi:[1,1,1]
    v_pk_fma_f32 v[70:71], v[192:193], v[70:71], v[38:39] op_sel:[1,0,0] op_sel_hi:[1,1,1]
    v_pk_mul_f32 v[32:33], v[64:65], v[64:65]
    v_pk_mul_f32 v[34:35], v[66:67], v[66:67]
    v_pk_mul_f32 v[36:37], v[68:69], v[68:69]
    v_pk_mul_f32 v[38:39], v[70:71], v[70:71]
    v_pk_fma_f32 v[32:33], v[32:33], v[2:3], v[2:3] op_sel:[0,1,0] op_sel_hi:[1,1,0]
    v_pk_fma_f32 v[34:35], v[34:35], v[2:3], v[2:3] op_sel:[0,1,0] op_sel_hi:[1,1,0]
    v_pk_fma_f32 v[36:37], v[36:37], v[2:3], v[2:3] op_sel:[0,1,0] op_sel_hi:[1,1,0]
    v_pk_fma_f32 v[38:39], v[38:39], v[2:3], v[2:3] op_sel:[0,1,0] op_sel_hi:[1,1,0]
    v_pk_mul_f32 v[32:33], v[32:33], v[64:65]
    v_pk_mul_f32 v[34:35], v[34:35], v[66:67]
    v_pk_mul_f32 v[36:37], v[36:37], v[68:69]
    v_pk_mul_f32 v[38:39], v[38:39], v[70:71]
    v_exp_f32 v40, v32
    v_exp_f32 v41, v33
    v_exp_f32 v42, v34
    v_exp_f32 v43, v35
    v_exp_f32 v44, v36
    v_exp_f32 v45, v37
    v_exp_f32 v46, v38
    v_exp_f32 v47, v39
    v_pk_add_f32 v[40:41], v[40:41], v[6:7] op_sel_hi:[1,0]
    v_pk_add_f32 v[42:43], v[42:43], v[6:7] op_sel_hi:[1,0]
    v_pk_add_f32 v[44:45], v[44:45], v[6:7] op_sel_hi:[1,0]
    v_pk_add_f32 v[46:47], v[46:47], v[6:7] op_sel_hi:[1,0]
    v_rcp_f32 v40, v40
    v_rcp_f32 v41, v41
    v_rcp_f32 v42, v42
    v_rcp_f32 v43, v43
    v_rcp_f32 v44, v44
    v_rcp_f32 v45, v45
    v_rcp_f32 v46, v46
    v_rcp_f32 v47, v47
    v_pk_mul_f32 v[40:41], v[40:41], v[64:65]
    v_pk_mul_f32 v[42:43], v[42:43], v[66:67]
    v_pk_mul_f32 v[44:45], v[44:45], v[68:69]
    v_pk_mul_f32 v[46:47], v[46:47], v[70:71]
    v_cvt_pk_bf16_f32 v196, v40, v41
    v_cvt_pk_bf16_f32 v197, v42, v43
    v_cvt_pk_bf16_f32 v198, v44, v45
    v_cvt_pk_bf16_f32 v199, v46, v47
    buffer_store_dwordx4 v[196:199], v4, s[36:39], s72 offen offset:0 sc1
    v_pk_fma_f32 v[32:33], v[192:193], v[136:137], v[168:169] op_sel_hi:[0,1,1]
    v_pk_fma_f32 v[34:35], v[192:193], v[138:139], v[170:171] op_sel_hi:[0,1,1]
    v_pk_fma_f32 v[36:37], v[192:193], v[140:141], v[172:173] op_sel_hi:[0,1,1]
    v_pk_fma_f32 v[38:39], v[192:193], v[142:143], v[174:175] op_sel_hi:[0,1,1]
    v_pk_fma_f32 v[72:73], v[192:193], v[72:73], v[32:33] op_sel:[1,0,0] op_sel_hi:[1,1,1]
    v_pk_fma_f32 v[74:75], v[192:193], v[74:75], v[34:35] op_sel:[1,0,0] op_sel_hi:[1,1,1]
    v_pk_fma_f32 v[76:77], v[192:193], v[76:77], v[36:37] op_sel:[1,0,0] op_sel_hi:[1,1,1]
    v_pk_fma_f32 v[78:79], v[192:193], v[78:79], v[38:39] op_sel:[1,0,0] op_sel_hi:[1,1,1]
    v_pk_mul_f32 v[32:33], v[72:73], v[72:73]
    v_pk_mul_f32 v[34:35], v[74:75], v[74:75]
    v_pk_mul_f32 v[36:37], v[76:77], v[76:77]
    v_pk_mul_f32 v[38:39], v[78:79], v[78:79]
    v_pk_fma_f32 v[32:33], v[32:33], v[2:3], v[2:3] op_sel:[0,1,0] op_sel_hi:[1,1,0]
    v_pk_fma_f32 v[34:35], v[34:35], v[2:3], v[2:3] op_sel:[0,1,0] op_sel_hi:[1,1,0]
    v_pk_fma_f32 v[36:37], v[36:37], v[2:3], v[2:3] op_sel:[0,1,0] op_sel_hi:[1,1,0]
    v_pk_fma_f32 v[38:39], v[38:39], v[2:3], v[2:3] op_sel:[0,1,0] op_sel_hi:[1,1,0]
    v_pk_mul_f32 v[32:33], v[32:33], v[72:73]
    v_pk_mul_f32 v[34:35], v[34:35], v[74:75]
    v_pk_mul_f32 v[36:37], v[36:37], v[76:77]
    v_pk_mul_f32 v[38:39], v[38:39], v[78:79]
    v_exp_f32 v40, v32
    v_exp_f32 v41, v33
    v_exp_f32 v42, v34
    v_exp_f32 v43, v35
    v_exp_f32 v44, v36
    v_exp_f32 v45, v37
    v_exp_f32 v46, v38
    v_exp_f32 v47, v39
    v_pk_add_f32 v[40:41], v[40:41], v[6:7] op_sel_hi:[1,0]
    v_pk_add_f32 v[42:43], v[42:43], v[6:7] op_sel_hi:[1,0]
    v_pk_add_f32 v[44:45], v[44:45], v[6:7] op_sel_hi:[1,0]
    v_pk_add_f32 v[46:47], v[46:47], v[6:7] op_sel_hi:[1,0]
    v_rcp_f32 v40, v40
    v_rcp_f32 v41, v41
    v_rcp_f32 v42, v42
    v_rcp_f32 v43, v43
    v_rcp_f32 v44, v44
    v_rcp_f32 v45, v45
    v_rcp_f32 v46, v46
    v_rcp_f32 v47, v47
    v_pk_mul_f32 v[40:41], v[40:41], v[72:73]
    v_pk_mul_f32 v[42:43], v[42:43], v[74:75]
    v_pk_mul_f32 v[44:45], v[44:45], v[76:77]
    v_pk_mul_f32 v[46:47], v[46:47], v[78:79]
    v_cvt_pk_bf16_f32 v200, v40, v41
    v_cvt_pk_bf16_f32 v201, v42, v43
    v_cvt_pk_bf16_f32 v202, v44, v45
    v_cvt_pk_bf16_f32 v203, v46, v47
    buffer_store_dwordx4 v[200:203], v4, s[36:39], s72 offen offset:1024 sc1
    v_pk_fma_f32 v[32:33], v[192:193], v[144:145], v[176:177] op_sel_hi:[0,1,1]
    v_pk_fma_f32 v[34:35], v[192:193], v[146:147], v[178:179] op_sel_hi:[0,1,1]
    v_pk_fma_f32 v[36:37], v[192:193], v[148:149], v[180:181] op_sel_hi:[0,1,1]
    v_pk_fma_f32 v[38:39], v[192:193], v[150:151], v[182:183] op_sel_hi:[0,1,1]
    v_pk_fma_f32 v[80:81], v[192:193], v[80:81], v[32:33] op_sel:[1,0,0] op_sel_hi:[1,1,1]
    v_pk_fma_f32 v[82:83], v[192:193], v[82:83], v[34:35] op_sel:[1,0,0] op_sel_hi:[1,1,1]
    v_pk_fma_f32 v[84:85], v[192:193], v[84:85], v[36:37] op_sel:[1,0,0] op_sel_hi:[1,1,1]
    v_pk_fma_f32 v[86:87], v[192:193], v[86:87], v[38:39] op_sel:[1,0,0] op_sel_hi:[1,1,1]
    v_pk_mul_f32 v[32:33], v[80:81], v[80:81]
    v_pk_mul_f32 v[34:35], v[82:83], v[82:83]
    v_pk_mul_f32 v[36:37], v[84:85], v[84:85]
    v_pk_mul_f32 v[38:39], v[86:87], v[86:87]
    v_pk_fma_f32 v[32:33], v[32:33], v[2:3], v[2:3] op_sel:[0,1,0] op_sel_hi:[1,1,0]
    v_pk_fma_f32 v[34:35], v[34:35], v[2:3], v[2:3] op_sel:[0,1,0] op_sel_hi:[1,1,0]
    v_pk_fma_f32 v[36:37], v[36:37], v[2:3], v[2:3] op_sel:[0,1,0] op_sel_hi:[1,1,0]
    v_pk_fma_f32 v[38:39], v[38:39], v[2:3], v[2:3] op_sel:[0,1,0] op_sel_hi:[1,1,0]
    v_pk_mul_f32 v[32:33], v[32:33], v[80:81]
    v_pk_mul_f32 v[34:35], v[34:35], v[82:83]
    v_pk_mul_f32 v[36:37], v[36:37], v[84:85]
    v_pk_mul_f32 v[38:39], v[38:39], v[86:87]
    v_exp_f32 v40, v32
    v_exp_f32 v41, v33
    v_exp_f32 v42, v34
    v_exp_f32 v43, v35
    v_exp_f32 v44, v36
    v_exp_f32 v45, v37
    v_exp_f32 v46, v38
    v_exp_f32 v47, v39
    v_pk_add_f32 v[40:41], v[40:41], v[6:7] op_sel_hi:[1,0]
    v_pk_add_f32 v[42:43], v[42:43], v[6:7] op_sel_hi:[1,0]
    v_pk_add_f32 v[44:45], v[44:45], v[6:7] op_sel_hi:[1,0]
    v_pk_add_f32 v[46:47], v[46:47], v[6:7] op_sel_hi:[1,0]
    v_rcp_f32 v40, v40
    v_rcp_f32 v41, v41
    v_rcp_f32 v42, v42
    v_rcp_f32 v43, v43
    v_rcp_f32 v44, v44
    v_rcp_f32 v45, v45
    v_rcp_f32 v46, v46
    v_rcp_f32 v47, v47
    v_pk_mul_f32 v[40:41], v[40:41], v[80:81]
    v_pk_mul_f32 v[42:43], v[42:43], v[82:83]
    v_pk_mul_f32 v[44:45], v[44:45], v[84:85]
    v_pk_mul_f32 v[46:47], v[46:47], v[86:87]
    v_cvt_pk_bf16_f32 v204, v40, v41
    v_cvt_pk_bf16_f32 v205, v42, v43
    v_cvt_pk_bf16_f32 v206, v44, v45
    v_cvt_pk_bf16_f32 v207, v46, v47
    buffer_store_dwordx4 v[204:207], v4, s[36:39], s72 offen offset:2048 sc1
    v_pk_fma_f32 v[32:33], v[192:193], v[152:153], v[184:185] op_sel_hi:[0,1,1]
    v_pk_fma_f32 v[34:35], v[192:193], v[154:155], v[186:187] op_sel_hi:[0,1,1]
    v_pk_fma_f32 v[36:37], v[192:193], v[156:157], v[188:189] op_sel_hi:[0,1,1]
    v_pk_fma_f32 v[38:39], v[192:193], v[158:159], v[190:191] op_sel_hi:[0,1,1]
    v_pk_fma_f32 v[88:89], v[192:193], v[88:89], v[32:33] op_sel:[1,0,0] op_sel_hi:[1,1,1]
    v_pk_fma_f32 v[90:91], v[192:193], v[90:91], v[34:35] op_sel:[1,0,0] op_sel_hi:[1,1,1]
    v_pk_fma_f32 v[92:93], v[192:193], v[92:93], v[36:37] op_sel:[1,0,0] op_sel_hi:[1,1,1]
    v_pk_fma_f32 v[94:95], v[192:193], v[94:95], v[38:39] op_sel:[1,0,0] op_sel_hi:[1,1,1]
    v_pk_mul_f32 v[32:33], v[88:89], v[88:89]
    v_pk_mul_f32 v[34:35], v[90:91], v[90:91]
    v_pk_mul_f32 v[36:37], v[92:93], v[92:93]
    v_pk_mul_f32 v[38:39], v[94:95], v[94:95]
    v_pk_fma_f32 v[32:33], v[32:33], v[2:3], v[2:3] op_sel:[0,1,0] op_sel_hi:[1,1,0]
    v_pk_fma_f32 v[34:35], v[34:35], v[2:3], v[2:3] op_sel:[0,1,0] op_sel_hi:[1,1,0]
    v_pk_fma_f32 v[36:37], v[36:37], v[2:3], v[2:3] op_sel:[0,1,0] op_sel_hi:[1,1,0]
    v_pk_fma_f32 v[38:39], v[38:39], v[2:3], v[2:3] op_sel:[0,1,0] op_sel_hi:[1,1,0]
    v_pk_mul_f32 v[32:33], v[32:33], v[88:89]
    v_pk_mul_f32 v[34:35], v[34:35], v[90:91]
    v_pk_mul_f32 v[36:37], v[36:37], v[92:93]
    v_pk_mul_f32 v[38:39], v[38:39], v[94:95]
    v_exp_f32 v40, v32
    v_exp_f32 v41, v33
    v_exp_f32 v42, v34
    v_exp_f32 v43, v35
    v_exp_f32 v44, v36
    v_exp_f32 v45, v37
    v_exp_f32 v46, v38
    v_exp_f32 v47, v39
    v_pk_add_f32 v[40:41], v[40:41], v[6:7] op_sel_hi:[1,0]
    v_pk_add_f32 v[42:43], v[42:43], v[6:7] op_sel_hi:[1,0]
    v_pk_add_f32 v[44:45], v[44:45], v[6:7] op_sel_hi:[1,0]
    v_pk_add_f32 v[46:47], v[46:47], v[6:7] op_sel_hi:[1,0]
    v_rcp_f32 v40, v40
    v_rcp_f32 v41, v41
    v_rcp_f32 v42, v42
    v_rcp_f32 v43, v43
    v_rcp_f32 v44, v44
    v_rcp_f32 v45, v45
    v_rcp_f32 v46, v46
    v_rcp_f32 v47, v47
    v_pk_mul_f32 v[40:41], v[40:41], v[88:89]
    v_pk_mul_f32 v[42:43], v[42:43], v[90:91]
    v_pk_mul_f32 v[44:45], v[44:45], v[92:93]
    v_pk_mul_f32 v[46:47], v[46:47], v[94:95]
    v_cvt_pk_bf16_f32 v208, v40, v41
    v_cvt_pk_bf16_f32 v209, v42, v43
    v_cvt_pk_bf16_f32 v210, v44, v45
    v_cvt_pk_bf16_f32 v211, v46, v47
    buffer_store_dwordx4 v[208:211], v4, s[36:39], s72 offen offset:3072 sc1
    s_add_u32 s72, s72, 110592
    v_pk_fma_f32 v[32:33], v[194:195], v[128:129], v[160:161] op_sel_hi:[0,1,1]
    v_pk_fma_f32 v[34:35], v[194:195], v[130:131], v[162:163] op_sel_hi:[0,1,1]
    v_pk_fma_f32 v[36:37], v[194:195], v[132:133], v[164:165] op_sel_hi:[0,1,1]
    v_pk_fma_f32 v[38:39], v[194:195], v[134:135], v[166:167] op_sel_hi:[0,1,1]
    v_pk_fma_f32 v[96:97], v[194:195], v[96:97], v[32:33] op_sel:[1,0,0] op_sel_hi:[1,1,1]
    v_pk_fma_f32 v[98:99], v[194:195], v[98:99], v[34:35] op_sel:[1,0,0] op_sel_hi:[1,1,1]
    v_pk_fma_f32 v[100:101], v[194:195], v[100:101], v[36:37] op_sel:[1,0,0] op_sel_hi:[1,1,1]
    v_pk_fma_f32 v[102:103], v[194:195], v[102:103], v[38:39] op_sel:[1,0,0] op_sel_hi:[1,1,1]
    v_pk_mul_f32 v[32:33], v[96:97], v[96:97]
    v_pk_mul_f32 v[34:35], v[98:99], v[98:99]
    v_pk_mul_f32 v[36:37], v[100:101], v[100:101]
    v_pk_mul_f32 v[38:39], v[102:103], v[102:103]
    v_pk_fma_f32 v[32:33], v[32:33], v[2:3], v[2:3] op_sel:[0,1,0] op_sel_hi:[1,1,0]
    v_pk_fma_f32 v[34:35], v[34:35], v[2:3], v[2:3] op_sel:[0,1,0] op_sel_hi:[1,1,0]
    v_pk_fma_f32 v[36:37], v[36:37], v[2:3], v[2:3] op_sel:[0,1,0] op_sel_hi:[1,1,0]
    v_pk_fma_f32 v[38:39], v[38:39], v[2:3], v[2:3] op_sel:[0,1,0] op_sel_hi:[1,1,0]
    v_pk_mul_f32 v[32:33], v[32:33], v[96:97]
    v_pk_mul_f32 v[34:35], v[34:35], v[98:99]
    v_pk_mul_f32 v[36:37], v[36:37], v[100:101]
    v_pk_mul_f32 v[38:39], v[38:39], v[102:103]
    v_exp_f32 v40, v32
    v_exp_f32 v41, v33
    v_exp_f32 v42, v34
    v_exp_f32 v43, v35
    v_exp_f32 v44, v36
    v_exp_f32 v45, v37
    v_exp_f32 v46, v38
    v_exp_f32 v47, v39
    v_pk_add_f32 v[40:41], v[40:41], v[6:7] op_sel_hi:[1,0]
    v_pk_add_f32 v[42:43], v[42:43], v[6:7] op_sel_hi:[1,0]
    v_pk_add_f32 v[44:45], v[44:45], v[6:7] op_sel_hi:[1,0]
    v_pk_add_f32 v[46:47], v[46:47], v[6:7] op_sel_hi:[1,0]
    v_rcp_f32 v40, v40
    v_rcp_f32 v41, v41
    v_rcp_f32 v42, v42
    v_rcp_f32 v43, v43
    v_rcp_f32 v44, v44
    v_rcp_f32 v45, v45
    v_rcp_f32 v46, v46
    v_rcp_f32 v47, v47
    v_pk_mul_f32 v[40:41], v[40:41], v[96:97]
    v_pk_mul_f32 v[42:43], v[42:43], v[98:99]
    v_pk_mul_f32 v[44:45], v[44:45], v[100:101]
    v_pk_mul_f32 v[46:47], v[46:47], v[102:103]
    v_cvt_pk_bf16_f32 v212, v40, v41
    v_cvt_pk_bf16_f32 v213, v42, v43
    v_cvt_pk_bf16_f32 v214, v44, v45
    v_cvt_pk_bf16_f32 v215, v46, v47
    buffer_store_dwordx4 v[212:215], v4, s[36:39], s72 offen offset:0 sc1
    v_pk_fma_f32 v[32:33], v[194:195], v[136:137], v[168:169] op_sel_hi:[0,1,1]
    v_pk_fma_f32 v[34:35], v[194:195], v[138:139], v[170:171] op_sel_hi:[0,1,1]
    v_pk_fma_f32 v[36:37], v[194:195], v[140:141], v[172:173] op_sel_hi:[0,1,1]
    v_pk_fma_f32 v[38:39], v[194:195], v[142:143], v[174:175] op_sel_hi:[0,1,1]
    v_pk_fma_f32 v[104:105], v[194:195], v[104:105], v[32:33] op_sel:[1,0,0] op_sel_hi:[1,1,1]
    v_pk_fma_f32 v[106:107], v[194:195], v[106:107], v[34:35] op_sel:[1,0,0] op_sel_hi:[1,1,1]
    v_pk_fma_f32 v[108:109], v[194:195], v[108:109], v[36:37] op_sel:[1,0,0] op_sel_hi:[1,1,1]
    v_pk_fma_f32 v[110:111], v[194:195], v[110:111], v[38:39] op_sel:[1,0,0] op_sel_hi:[1,1,1]
    v_pk_mul_f32 v[32:33], v[104:105], v[104:105]
    v_pk_mul_f32 v[34:35], v[106:107], v[106:107]
    v_pk_mul_f32 v[36:37], v[108:109], v[108:109]
    v_pk_mul_f32 v[38:39], v[110:111], v[110:111]
    v_pk_fma_f32 v[32:33], v[32:33], v[2:3], v[2:3] op_sel:[0,1,0] op_sel_hi:[1,1,0]
    v_pk_fma_f32 v[34:35], v[34:35], v[2:3], v[2:3] op_sel:[0,1,0] op_sel_hi:[1,1,0]
    v_pk_fma_f32 v[36:37], v[36:37], v[2:3], v[2:3] op_sel:[0,1,0] op_sel_hi:[1,1,0]
    v_pk_fma_f32 v[38:39], v[38:39], v[2:3], v[2:3] op_sel:[0,1,0] op_sel_hi:[1,1,0]
    v_pk_mul_f32 v[32:33], v[32:33], v[104:105]
    v_pk_mul_f32 v[34:35], v[34:35], v[106:107]
    v_pk_mul_f32 v[36:37], v[36:37], v[108:109]
    v_pk_mul_f32 v[38:39], v[38:39], v[110:111]
    v_exp_f32 v40, v32
    v_exp_f32 v41, v33
    v_exp_f32 v42, v34
    v_exp_f32 v43, v35
    v_exp_f32 v44, v36
    v_exp_f32 v45, v37
    v_exp_f32 v46, v38
    v_exp_f32 v47, v39
    v_pk_add_f32 v[40:41], v[40:41], v[6:7] op_sel_hi:[1,0]
    v_pk_add_f32 v[42:43], v[42:43], v[6:7] op_sel_hi:[1,0]
    v_pk_add_f32 v[44:45], v[44:45], v[6:7] op_sel_hi:[1,0]
    v_pk_add_f32 v[46:47], v[46:47], v[6:7] op_sel_hi:[1,0]
    v_rcp_f32 v40, v40
    v_rcp_f32 v41, v41
    v_rcp_f32 v42, v42
    v_rcp_f32 v43, v43
    v_rcp_f32 v44, v44
    v_rcp_f32 v45, v45
    v_rcp_f32 v46, v46
    v_rcp_f32 v47, v47
    v_pk_mul_f32 v[40:41], v[40:41], v[104:105]
    v_pk_mul_f32 v[42:43], v[42:43], v[106:107]
    v_pk_mul_f32 v[44:45], v[44:45], v[108:109]
    v_pk_mul_f32 v[46:47], v[46:47], v[110:111]
    v_cvt_pk_bf16_f32 v216, v40, v41
    v_cvt_pk_bf16_f32 v217, v42, v43
    v_cvt_pk_bf16_f32 v218, v44, v45
    v_cvt_pk_bf16_f32 v219, v46, v47
    buffer_store_dwordx4 v[216:219], v4, s[36:39], s72 offen offset:1024 sc1
    v_pk_fma_f32 v[32:33], v[194:195], v[144:145], v[176:177] op_sel_hi:[0,1,1]
    v_pk_fma_f32 v[34:35], v[194:195], v[146:147], v[178:179] op_sel_hi:[0,1,1]
    v_pk_fma_f32 v[36:37], v[194:195], v[148:149], v[180:181] op_sel_hi:[0,1,1]
    v_pk_fma_f32 v[38:39], v[194:195], v[150:151], v[182:183] op_sel_hi:[0,1,1]
    v_pk_fma_f32 v[112:113], v[194:195], v[112:113], v[32:33] op_sel:[1,0,0] op_sel_hi:[1,1,1]
    v_pk_fma_f32 v[114:115], v[194:195], v[114:115], v[34:35] op_sel:[1,0,0] op_sel_hi:[1,1,1]
    v_pk_fma_f32 v[116:117], v[194:195], v[116:117], v[36:37] op_sel:[1,0,0] op_sel_hi:[1,1,1]
    v_pk_fma_f32 v[118:119], v[194:195], v[118:119], v[38:39] op_sel:[1,0,0] op_sel_hi:[1,1,1]
    v_pk_mul_f32 v[32:33], v[112:113], v[112:113]
    v_pk_mul_f32 v[34:35], v[114:115], v[114:115]
    v_pk_mul_f32 v[36:37], v[116:117], v[116:117]
    v_pk_mul_f32 v[38:39], v[118:119], v[118:119]
    v_pk_fma_f32 v[32:33], v[32:33], v[2:3], v[2:3] op_sel:[0,1,0] op_sel_hi:[1,1,0]
    v_pk_fma_f32 v[34:35], v[34:35], v[2:3], v[2:3] op_sel:[0,1,0] op_sel_hi:[1,1,0]
    v_pk_fma_f32 v[36:37], v[36:37], v[2:3], v[2:3] op_sel:[0,1,0] op_sel_hi:[1,1,0]
    v_pk_fma_f32 v[38:39], v[38:39], v[2:3], v[2:3] op_sel:[0,1,0] op_sel_hi:[1,1,0]
    v_pk_mul_f32 v[32:33], v[32:33], v[112:113]
    v_pk_mul_f32 v[34:35], v[34:35], v[114:115]
    v_pk_mul_f32 v[36:37], v[36:37], v[116:117]
    v_pk_mul_f32 v[38:39], v[38:39], v[118:119]
    v_exp_f32 v40, v32
    v_exp_f32 v41, v33
    v_exp_f32 v42, v34
    v_exp_f32 v43, v35
    v_exp_f32 v44, v36
    v_exp_f32 v45, v37
    v_exp_f32 v46, v38
    v_exp_f32 v47, v39
    v_pk_add_f32 v[40:41], v[40:41], v[6:7] op_sel_hi:[1,0]
    v_pk_add_f32 v[42:43], v[42:43], v[6:7] op_sel_hi:[1,0]
    v_pk_add_f32 v[44:45], v[44:45], v[6:7] op_sel_hi:[1,0]
    v_pk_add_f32 v[46:47], v[46:47], v[6:7] op_sel_hi:[1,0]
    v_rcp_f32 v40, v40
    v_rcp_f32 v41, v41
    v_rcp_f32 v42, v42
    v_rcp_f32 v43, v43
    v_rcp_f32 v44, v44
    v_rcp_f32 v45, v45
    v_rcp_f32 v46, v46
    v_rcp_f32 v47, v47
    v_pk_mul_f32 v[40:41], v[40:41], v[112:113]
    v_pk_mul_f32 v[42:43], v[42:43], v[114:115]
    v_pk_mul_f32 v[44:45], v[44:45], v[116:117]
    v_pk_mul_f32 v[46:47], v[46:47], v[118:119]
    v_cvt_pk_bf16_f32 v220, v40, v41
    v_cvt_pk_bf16_f32 v221, v42, v43
    v_cvt_pk_bf16_f32 v222, v44, v45
    v_cvt_pk_bf16_f32 v223, v46, v47
    buffer_store_dwordx4 v[220:223], v4, s[36:39], s72 offen offset:2048 sc1
    v_pk_fma_f32 v[32:33], v[194:195], v[152:153], v[184:185] op_sel_hi:[0,1,1]
    v_pk_fma_f32 v[34:35], v[194:195], v[154:155], v[186:187] op_sel_hi:[0,1,1]
    v_pk_fma_f32 v[36:37], v[194:195], v[156:157], v[188:189] op_sel_hi:[0,1,1]
    v_pk_fma_f32 v[38:39], v[194:195], v[158:159], v[190:191] op_sel_hi:[0,1,1]
    v_pk_fma_f32 v[120:121], v[194:195], v[120:121], v[32:33] op_sel:[1,0,0] op_sel_hi:[1,1,1]
    v_pk_fma_f32 v[122:123], v[194:195], v[122:123], v[34:35] op_sel:[1,0,0] op_sel_hi:[1,1,1]
    v_pk_fma_f32 v[124:125], v[194:195], v[124:125], v[36:37] op_sel:[1,0,0] op_sel_hi:[1,1,1]
    v_pk_fma_f32 v[126:127], v[194:195], v[126:127], v[38:39] op_sel:[1,0,0] op_sel_hi:[1,1,1]
    v_pk_mul_f32 v[32:33], v[120:121], v[120:121]
    v_pk_mul_f32 v[34:35], v[122:123], v[122:123]
    v_pk_mul_f32 v[36:37], v[124:125], v[124:125]
    v_pk_mul_f32 v[38:39], v[126:127], v[126:127]
    v_pk_fma_f32 v[32:33], v[32:33], v[2:3], v[2:3] op_sel:[0,1,0] op_sel_hi:[1,1,0]
    v_pk_fma_f32 v[34:35], v[34:35], v[2:3], v[2:3] op_sel:[0,1,0] op_sel_hi:[1,1,0]
    v_pk_fma_f32 v[36:37], v[36:37], v[2:3], v[2:3] op_sel:[0,1,0] op_sel_hi:[1,1,0]
    v_pk_fma_f32 v[38:39], v[38:39], v[2:3], v[2:3] op_sel:[0,1,0] op_sel_hi:[1,1,0]
    v_pk_mul_f32 v[32:33], v[32:33], v[120:121]
    v_pk_mul_f32 v[34:35], v[34:35], v[122:123]
    v_pk_mul_f32 v[36:37], v[36:37], v[124:125]
    v_pk_mul_f32 v[38:39], v[38:39], v[126:127]
    v_exp_f32 v40, v32
    v_exp_f32 v41, v33
    v_exp_f32 v42, v34
    v_exp_f32 v43, v35
    v_exp_f32 v44, v36
    v_exp_f32 v45, v37
    v_exp_f32 v46, v38
    v_exp_f32 v47, v39
    v_pk_add_f32 v[40:41], v[40:41], v[6:7] op_sel_hi:[1,0]
    v_pk_add_f32 v[42:43], v[42:43], v[6:7] op_sel_hi:[1,0]
    v_pk_add_f32 v[44:45], v[44:45], v[6:7] op_sel_hi:[1,0]
    v_pk_add_f32 v[46:47], v[46:47], v[6:7] op_sel_hi:[1,0]
    v_rcp_f32 v40, v40
    v_rcp_f32 v41, v41
    v_rcp_f32 v42, v42
    v_rcp_f32 v43, v43
    v_rcp_f32 v44, v44
    v_rcp_f32 v45, v45
    v_rcp_f32 v46, v46
    v_rcp_f32 v47, v47
    v_pk_mul_f32 v[40:41], v[40:41], v[120:121]
    v_pk_mul_f32 v[42:43], v[42:43], v[122:123]
    v_pk_mul_f32 v[44:45], v[44:45], v[124:125]
    v_pk_mul_f32 v[46:47], v[46:47], v[126:127]
    v_cvt_pk_bf16_f32 v224, v40, v41
    v_cvt_pk_bf16_f32 v225, v42, v43
    v_cvt_pk_bf16_f32 v226, v44, v45
    v_cvt_pk_bf16_f32 v227, v46, v47
    buffer_store_dwordx4 v[224:227], v4, s[36:39], s72 offen offset:3072 sc1
    s_branch s1_join
s1_g0:
    s_and_b32 s48, s90, 1
    s_lshl_b32 s48, s48, 13
    v_and_b32 v26, 31, v1
    v_lshrrev_b32 v27, 5, v1
    v_bfe_u32 v28, v1, 1, 3
    v_lshlrev_b32 v26, 7, v26
    v_add_u32 v26, s48, v26
    v_or_b32 v29, 0, v27
    v_xor_b32 v29, v29, v28
    v_lshl_add_u32 v14, v29, 4, v26
    v_add_u32 v18, 65536, v14
    v_or_b32 v29, 2, v27
    v_xor_b32 v29, v29, v28
    v_lshl_add_u32 v15, v29, 4, v26
    v_add_u32 v19, 65536, v15
    v_or_b32 v29, 4, v27
    v_xor_b32 v29, v29, v28
    v_lshl_add_u32 v16, v29, 4, v26
    v_add_u32 v20, 65536, v16
    v_or_b32 v29, 6, v27
    v_xor_b32 v29, v29, v28
    v_lshl_add_u32 v17, v29, 4, v26
    v_add_u32 v21, 65536, v17
    v_bfe_u32 v26, v1, 2, 2
    v_lshl_add_u32 v27, v27, 3, v26
    v_lshlrev_b32 v27, 8, v27
    v_bfe_u32 v28, v1, 4, 1
    v_lshl_add_u32 v27, v28, 5, v27
    v_and_b32 v28, 3, v1
    v_lshl_add_u32 v27, v28, 3, v27
    s_and_b32 s48, s90, 2
    s_or_b32 s49, s48, 0
    v_xor_b32 v28, s49, v26
    v_lshl_add_u32 v22, v28, 6, v27
    v_add_u32 v24, 65536, v22
    s_or_b32 s49, s48, 1
    v_xor_b32 v28, s49, v26
    v_lshl_add_u32 v23, v28, 6, v27
    v_add_u32 v25, 65536, v23
    s_setprio 3
    s_barrier
    ds_read_b128 v[32:35], v18 offset:32768
    ds_read_b64_tr_b16 v[40:41], v24 offset:49152
    ds_read_b64_tr_b16 v[42:43], v24 offset:50176
    ds_read_b128 v[36:39], v18 offset:36864
    ds_read_b64_tr_b16 v[44:45], v25 offset:49152
    ds_read_b64_tr_b16 v[46:47], v25 offset:50176
    ds_read_b128 v[48:51], v19 offset:32768
    ds_read_b64_tr_b16 v[56:57], v24 offset:53248
    s_waitcnt lgkmcnt(5)
    v_mfma_f32_32x32x16_bf16 v[64:79], v[40:43], v[32:35], 0
    ds_read_b64_tr_b16 v[58:59], v24 offset:54272
    ds_read_b128 v[52:55], v19 offset:36864
    ds_read_b64_tr_b16 v[60:61], v25 offset:53248
    s_waitcnt lgkmcnt(7)
    v_mfma_f32_32x32x16_bf16 v[96:111], v[40:43], v[36:39], 0
    ds_read_b64_tr_b16 v[62:63], v25 offset:54272
    s_waitcnt lgkmcnt(6)
    v_mfma_f32_32x32x16_bf16 v[80:95], v[44:47], v[32:35], 0
    v_mfma_f32_32x32x16_bf16 v[112:127], v[44:47], v[36:39], 0
    ds_read_b128 v[32:35], v20 offset:32768
    ds_read_b64_tr_b16 v[40:41], v24 offset:57344
    s_waitcnt lgkmcnt(5)
    v_mfma_f32_32x32x16_bf16 v[64:79], v[56:59], v[48:51], v[64:79]
    ds_read_b64_tr_b16 v[42:43], v24 offset:58368
    ds_read_b128 v[36:39], v20 offset:36864
    ds_read_b64_tr_b16 v[44:45], v25 offset:57344
    s_waitcnt lgkmcnt(7)
    v_mfma_f32_32x32x16_bf16 v[96:111], v[56:59], v[52:55], v[96:111]
    ds_read_b64_tr_b16 v[46:47], v25 offset:58368
    s_waitcnt lgkmcnt(6)
    v_mfma_f32_32x32x16_bf16 v[80:95], v[60:63], v[48:51], v[80:95]
    v_mfma_f32_32x32x16_bf16 v[112:127], v[60:63], v[52:55], v[112:127]
    ds_read_b128 v[48:51], v21 offset:32768
    ds_read_b64_tr_b16 v[56:57], v24 offset:61440
    s_waitcnt lgkmcnt(5)
    v_mfma_f32_32x32x16_bf16 v[64:79], v[40:43], v[32:35], v[64:79]
    ds_read_b64_tr_b16 v[58:59], v24 offset:62464
    ds_read_b128 v[52:55], v21 offset:36864
    ds_read_b64_tr_b16 v[60:61], v25 offset:61440
    s_waitcnt lgkmcnt(7)
    v_mfma_f32_32x32x16_bf16 v[96:111], v[40:43], v[36:39], v[96:111]
    ds_read_b64_tr_b16 v[62:63], v25 offset:62464
    s_waitcnt lgkmcnt(6)
    v_mfma_f32_32x32x16_bf16 v[80:95], v[44:47], v[32:35], v[80:95]
    v_mfma_f32_32x32x16_bf16 v[112:127], v[44:47], v[36:39], v[112:127]
    s_waitcnt lgkmcnt(0)
    s_barrier
    ds_read_b128 v[32:35], v14 offset:0
    ds_read_b64_tr_b16 v[40:41], v22 offset:16384
    v_mfma_f32_32x32x16_bf16 v[64:79], v[56:59], v[48:51], v[64:79]
    ds_read_b64_tr_b16 v[42:43], v22 offset:17408
    ds_read_b128 v[36:39], v14 offset:4096
    ds_read_b64_tr_b16 v[44:45], v23 offset:16384
    v_mfma_f32_32x32x16_bf16 v[96:111], v[56:59], v[52:55], v[96:111]
    ds_read_b64_tr_b16 v[46:47], v23 offset:17408
    v_mfma_f32_32x32x16_bf16 v[80:95], v[60:63], v[48:51], v[80:95]
    v_mfma_f32_32x32x16_bf16 v[112:127], v[60:63], v[52:55], v[112:127]
    ds_read_b128 v[48:51], v15 offset:0
    ds_read_b64_tr_b16 v[56:57], v22 offset:20480
    s_waitcnt lgkmcnt(5)
    v_mfma_f32_32x32x16_bf16 v[64:79], v[40:43], v[32:35], v[64:79]
    ds_read_b64_tr_b16 v[58:59], v22 offset:21504
    ds_read_b128 v[52:55], v15 offset:4096
    ds_read_b64_tr_b16 v[60:61], v23 offset:20480
    s_waitcnt lgkmcnt(7)
    v_mfma_f32_32x32x16_bf16 v[96:111], v[40:43], v[36:39], v[96:111]
    ds_read_b64_tr_b16 v[62:63], v23 offset:21504
    s_waitcnt lgkmcnt(6)
    v_mfma_f32_32x32x16_bf16 v[80:95], v[44:47], v[32:35], v[80:95]
    v_mfma_f32_32x32x16_bf16 v[112:127], v[44:47], v[36:39], v[112:127]
    ds_read_b128 v[32:35], v16 offset:0
    ds_read_b64_tr_b16 v[40:41], v22 offset:24576
    s_waitcnt lgkmcnt(5)
    v_mfma_f32_32x32x16_bf16 v[64:79], v[56:59], v[48:51], v[64:79]
    ds_read_b64_tr_b16 v[42:43], v22 offset:25600
    ds_read_b128 v[36:39], v16 offset:4096
    ds_read_b64_tr_b16 v[44:45], v23 offset:24576
    s_waitcnt lgkmcnt(7)
    v_mfma_f32_32x32x16_bf16 v[96:111], v[56:59], v[52:55], v[96:111]
    ds_read_b64_tr_b16 v[46:47], v23 offset:25600
    s_waitcnt lgkmcnt(6)
    v_mfma_f32_32x32x16_bf16 v[80:95], v[60:63], v[48:51], v[80:95]
    v_mfma_f32_32x32x16_bf16 v[112:127], v[60:63], v[52:55], v[112:127]
    ds_read_b128 v[48:51], v17 offset:0
    ds_read_b64_tr_b16 v[56:57], v22 offset:28672
    s_waitcnt lgkmcnt(5)
    v_mfma_f32_32x32x16_bf16 v[64:79], v[40:43], v[32:35], v[64:79]
    ds_read_b64_tr_b16 v[58:59], v22 offset:29696
    ds_read_b128 v[52:55], v17 offset:4096
    ds_read_b64_tr_b16 v[60:61], v23 offset:28672
    s_waitcnt lgkmcnt(7)
    v_mfma_f32_32x32x16_bf16 v[96:111], v[40:43], v[36:39], v[96:111]
    ds_read_b64_tr_b16 v[62:63], v23 offset:29696
    s_waitcnt lgkmcnt(6)
    v_mfma_f32_32x32x16_bf16 v[80:95], v[44:47], v[32:35], v[80:95]
    v_mfma_f32_32x32x16_bf16 v[112:127], v[44:47], v[36:39], v[112:127]
    s_waitcnt lgkmcnt(0)
    s_barrier
    ds_read_b128 v[32:35], v14 offset:32768
    ds_read_b64_tr_b16 v[40:41], v22 offset:49152
    v_mfma_f32_32x32x16_bf16 v[64:79], v[56:59], v[48:51], v[64:79]
    ds_read_b64_tr_b16 v[42:43], v22 offset:50176
    ds_read_b128 v[36:39], v14 offset:36864
    ds_read_b64_tr_b16 v[44:45], v23 offset:49152
    v_mfma_f32_32x32x16_bf16 v[96:111], v[56:59], v[52:55], v[96:111]
    ds_read_b64_tr_b16 v[46:47], v23 offset:50176
    v_mfma_f32_32x32x16_bf16 v[80:95], v[60:63], v[48:51], v[80:95]
    v_mfma_f32_32x32x16_bf16 v[112:127], v[60:63], v[52:55], v[112:127]
    ds_read_b128 v[48:51], v15 offset:32768
    ds_read_b64_tr_b16 v[56:57], v22 offset:53248
    s_waitcnt lgkmcnt(5)
    v_mfma_f32_32x32x16_bf16 v[64:79], v[40:43], v[32:35], v[64:79]
    ds_read_b64_tr_b16 v[58:59], v22 offset:54272
    ds_read_b128 v[52:55], v15 offset:36864
    ds_read_b64_tr_b16 v[60:61], v23 offset:53248
    s_waitcnt lgkmcnt(7)
    v_mfma_f32_32x32x16_bf16 v[96:111], v[40:43], v[36:39], v[96:111]
    ds_read_b64_tr_b16 v[62:63], v23 offset:54272
    s_waitcnt lgkmcnt(6)
    v_mfma_f32_32x32x16_bf16 v[80:95], v[44:47], v[32:35], v[80:95]
    v_mfma_f32_32x32x16_bf16 v[112:127], v[44:47], v[36:39], v[112:127]
    ds_read_b128 v[32:35], v16 offset:32768
    ds_read_b64_tr_b16 v[40:41], v22 offset:57344
    s_waitcnt lgkmcnt(5)
    v_mfma_f32_32x32x16_bf16 v[64:79], v[56:59], v[48:51], v[64:79]
    ds_read_b64_tr_b16 v[42:43], v22 offset:58368
    ds_read_b128 v[36:39], v16 offset:36864
    ds_read_b64_tr_b16 v[44:45], v23 offset:57344
    s_waitcnt lgkmcnt(7)
    v_mfma_f32_32x32x16_bf16 v[96:111], v[56:59], v[52:55], v[96:111]
    ds_read_b64_tr_b16 v[46:47], v23 offset:58368
    s_waitcnt lgkmcnt(6)
    v_mfma_f32_32x32x16_bf16 v[80:95], v[60:63], v[48:51], v[80:95]
    v_mfma_f32_32x32x16_bf16 v[112:127], v[60:63], v[52:55], v[112:127]
    v_mov_b32 v253, 0
    global_load_dword v252, v253, s[24:25] sc1
    ds_read_b128 v[48:51], v17 offset:32768
    ds_read_b64_tr_b16 v[56:57], v22 offset:61440
    s_waitcnt lgkmcnt(5)
    v_mfma_f32_32x32x16_bf16 v[64:79], v[40:43], v[32:35], v[64:79]
    ds_read_b64_tr_b16 v[58:59], v22 offset:62464
    ds_read_b128 v[52:55], v17 offset:36864
    ds_read_b64_tr_b16 v[60:61], v23 offset:61440
    s_waitcnt lgkmcnt(7)
    v_mfma_f32_32x32x16_bf16 v[96:111], v[40:43], v[36:39], v[96:111]
    ds_read_b64_tr_b16 v[62:63], v23 offset:62464
    s_waitcnt lgkmcnt(6)
    v_mfma_f32_32x32x16_bf16 v[80:95], v[44:47], v[32:35], v[80:95]
    v_mfma_f32_32x32x16_bf16 v[112:127], v[44:47], v[36:39], v[112:127]
    s_waitcnt lgkmcnt(0)
    s_barrier
    ds_read_b128 v[32:35], v18 offset:0
    ds_read_b64_tr_b16 v[40:41], v24 offset:16384
    v_mfma_f32_32x32x16_bf16 v[64:79], v[56:59], v[48:51], v[64:79]
    ds_read_b64_tr_b16 v[42:43], v24 offset:17408
    ds_read_b128 v[36:39], v18 offset:4096
    ds_read_b64_tr_b16 v[44:45], v25 offset:16384
    v_mfma_f32_32x32x16_bf16 v[96:111], v[56:59], v[52:55], v[96:111]
    ds_read_b64_tr_b16 v[46:47], v25 offset:17408
    v_mfma_f32_32x32x16_bf16 v[80:95], v[60:63], v[48:51], v[80:95]
    v_mfma_f32_32x32x16_bf16 v[112:127], v[60:63], v[52:55], v[112:127]
    ds_read_b128 v[48:51], v19 offset:0
    ds_read_b64_tr_b16 v[56:57], v24 offset:20480
    s_waitcnt lgkmcnt(5)
    v_mfma_f32_32x32x16_bf16 v[64:79], v[40:43], v[32:35], v[64:79]
    ds_read_b64_tr_b16 v[58:59], v24 offset:21504
    ds_read_b128 v[52:55], v19 offset:4096
    ds_read_b64_tr_b16 v[60:61], v25 offset:20480
    s_waitcnt lgkmcnt(7)
    v_mfma_f32_32x32x16_bf16 v[96:111], v[40:43], v[36:39], v[96:111]
    ds_read_b64_tr_b16 v[62:63], v25 offset:21504
    s_waitcnt lgkmcnt(6)
    v_mfma_f32_32x32x16_bf16 v[80:95], v[44:47], v[32:35], v[80:95]
    v_mfma_f32_32x32x16_bf16 v[112:127], v[44:47], v[36:39], v[112:127]
    ds_read_b128 v[32:35], v20 offset:0
    ds_read_b64_tr_b16 v[40:41], v24 offset:24576
    s_waitcnt lgkmcnt(5)
    v_mfma_f32_32x32x16_bf16 v[64:79], v[56:59], v[48:51], v[64:79]
    ds_read_b64_tr_b16 v[42:43], v24 offset:25600
    ds_read_b128 v[36:39], v20 offset:4096
    ds_read_b64_tr_b16 v[44:45], v25 offset:24576
    s_waitcnt lgkmcnt(7)
    v_mfma_f32_32x32x16_bf16 v[96:111], v[56:59], v[52:55], v[96:111]
    ds_read_b64_tr_b16 v[46:47], v25 offset:25600
    s_waitcnt lgkmcnt(6)
    v_mfma_f32_32x32x16_bf16 v[80:95], v[60:63], v[48:51], v[80:95]
    v_mfma_f32_32x32x16_bf16 v[112:127], v[60:63], v[52:55], v[112:127]
    ds_read_b128 v[48:51], v21 offset:0
    ds_read_b64_tr_b16 v[56:57], v24 offset:28672
    s_waitcnt lgkmcnt(5)
    v_mfma_f32_32x32x16_bf16 v[64:79], v[40:43], v[32:35], v[64:79]
    ds_read_b64_tr_b16 v[58:59], v24 offset:29696
    ds_read_b128 v[52:55], v21 offset:4096
    ds_read_b64_tr_b16 v[60:61], v25 offset:28672
    s_waitcnt lgkmcnt(7)
    v_mfma_f32_32x32x16_bf16 v[96:111], v[40:43], v[36:39], v[96:111]
    ds_read_b64_tr_b16 v[62:63], v25 offset:29696
    s_waitcnt lgkmcnt(6)
    v_mfma_f32_32x32x16_bf16 v[80:95], v[44:47], v[32:35], v[80:95]
    v_mfma_f32_32x32x16_bf16 v[112:127], v[44:47], v[36:39], v[112:127]
    s_waitcnt lgkmcnt(0)
    s_barrier
    ds_read_b128 v[32:35], v18 offset:32768
    ds_read_b64_tr_b16 v[40:41], v24 offset:49152
    v_mfma_f32_32x32x16_bf16 v[64:79], v[56:59], v[48:51], v[64:79]
    ds_read_b64_tr_b16 v[42:43], v24 offset:50176
    ds_read_b128 v[36:39], v18 offset:36864
    ds_read_b64_tr_b16 v[44:45], v25 offset:49152
    v_mfma_f32_32x32x16_bf16 v[96:111], v[56:59], v[52:55], v[96:111]
    ds_read_b64_tr_b16 v[46:47], v25 offset:50176
    v_mfma_f32_32x32x16_bf16 v[80:95], v[60:63], v[48:51], v[80:95]
    v_mfma_f32_32x32x16_bf16 v[112:127], v[60:63], v[52:55], v[112:127]
    ds_read_b128 v[48:51], v19 offset:32768
    ds_read_b64_tr_b16 v[56:57], v24 offset:53248
    s_waitcnt lgkmcnt(5)
    v_mfma_f32_32x32x16_bf16 v[64:79], v[40:43], v[32:35], v[64:79]
    ds_read_b64_tr_b16 v[58:59], v24 offset:54272
    ds_read_b128 v[52:55], v19 offset:36864
    ds_read_b64_tr_b16 v[60:61], v25 offset:53248
    s_waitcnt lgkmcnt(7)
    v_mfma_f32_32x32x16_bf16 v[96:111], v[40:43], v[36:39], v[96:111]
    ds_read_b64_tr_b16 v[62:63], v25 offset:54272
    s_waitcnt lgkmcnt(6)
    v_mfma_f32_32x32x16_bf16 v[80:95], v[44:47], v[32:35], v[80:95]
    v_mfma_f32_32x32x16_bf16 v[112:127], v[44:47], v[36:39], v[112:127]
    ds_read_b128 v[32:35], v20 offset:32768
    ds_read_b64_tr_b16 v[40:41], v24 offset:57344
    s_waitcnt lgkmcnt(5)
    v_mfma_f32_32x32x16_bf16 v[64:79], v[56:59], v[48:51], v[64:79]
    ds_read_b64_tr_b16 v[42:43], v24 offset:58368
    ds_read_b128 v[36:39], v20 offset:36864
    ds_read_b64_tr_b16 v[44:45], v25 offset:57344
    s_waitcnt lgkmcnt(7)
    v_mfma_f32_32x32x16_bf16 v[96:111], v[56:59], v[52:55], v[96:111]
    ds_read_b64_tr_b16 v[46:47], v25 offset:58368
    s_waitcnt lgkmcnt(6)
    v_mfma_f32_32x32x16_bf16 v[80:95], v[60:63], v[48:51], v[80:95]
    v_mfma_f32_32x32x16_bf16 v[112:127], v[60:63], v[52:55], v[112:127]
    s_waitcnt vmcnt(0)
ng_5:
    v_readfirstlane_b32 s96, v252
    s_nop 0
    s_cmp_lg_u32 s96, 0
    s_cbranch_scc1 ng_5_ok
    s_sleep 2
    global_load_dword v252, v253, s[24:25] sc1
    s_waitcnt vmcnt(0)
    s_branch ng_5
ng_5_ok:
    ds_read_b128 v[48:51], v21 offset:32768
    ds_read_b64_tr_b16 v[56:57], v24 offset:61440
    s_waitcnt lgkmcnt(5)
    v_mfma_f32_32x32x16_bf16 v[64:79], v[40:43], v[32:35], v[64:79]
    ds_read_b64_tr_b16 v[58:59], v24 offset:62464
    ds_read_b128 v[52:55], v21 offset:36864
    ds_read_b64_tr_b16 v[60:61], v25 offset:61440
    s_waitcnt lgkmcnt(7)
    v_mfma_f32_32x32x16_bf16 v[96:111], v[40:43], v[36:39], v[96:111]
    ds_read_b64_tr_b16 v[62:63], v25 offset:62464
    s_waitcnt lgkmcnt(6)
    v_mfma_f32_32x32x16_bf16 v[80:95], v[44:47], v[32:35], v[80:95]
    v_mfma_f32_32x32x16_bf16 v[112:127], v[44:47], v[36:39], v[112:127]
    s_waitcnt lgkmcnt(0)
    s_barrier
    ds_read_b128 v[32:35], v14 offset:0
    ds_read_b64_tr_b16 v[40:41], v22 offset:16384
    v_mfma_f32_32x32x16_bf16 v[64:79], v[56:59], v[48:51], v[64:79]
    ds_read_b64_tr_b16 v[42:43], v22 offset:17408
    ds_read_b128 v[36:39], v14 offset:4096
    ds_read_b64_tr_b16 v[44:45], v23 offset:16384
    v_mfma_f32_32x32x16_bf16 v[96:111], v[56:59], v[52:55], v[96:111]
    ds_read_b64_tr_b16 v[46:47], v23 offset:17408
    v_mfma_f32_32x32x16_bf16 v[80:95], v[60:63], v[48:51], v[80:95]
    v_mfma_f32_32x32x16_bf16 v[112:127], v[60:63], v[52:55], v[112:127]
    ds_read_b128 v[48:51], v15 offset:0
    ds_read_b64_tr_b16 v[56:57], v22 offset:20480
    s_waitcnt lgkmcnt(5)
    v_mfma_f32_32x32x16_bf16 v[64:79], v[40:43], v[32:35], v[64:79]
    ds_read_b64_tr_b16 v[58:59], v22 offset:21504
    ds_read_b128 v[52:55], v15 offset:4096
    ds_read_b64_tr_b16 v[60:61], v23 offset:20480
    s_waitcnt lgkmcnt(7)
    v_mfma_f32_32x32x16_bf16 v[96:111], v[40:43], v[36:39], v[96:111]
    ds_read_b64_tr_b16 v[62:63], v23 offset:21504
    s_waitcnt lgkmcnt(6)
    v_mfma_f32_32x32x16_bf16 v[80:95], v[44:47], v[32:35], v[80:95]
    v_mfma_f32_32x32x16_bf16 v[112:127], v[44:47], v[36:39], v[112:127]
    ds_read_b128 v[32:35], v16 offset:0
    ds_read_b64_tr_b16 v[40:41], v22 offset:24576
    s_waitcnt lgkmcnt(5)
    v_mfma_f32_32x32x16_bf16 v[64:79], v[56:59], v[48:51], v[64:79]
    ds_read_b64_tr_b16 v[42:43], v22 offset:25600
    ds_read_b128 v[36:39], v16 offset:4096
    ds_read_b64_tr_b16 v[44:45], v23 offset:24576
    s_waitcnt lgkmcnt(7)
    v_mfma_f32_32x32x16_bf16 v[96:111], v[56:59], v[52:55], v[96:111]
    ds_read_b64_tr_b16 v[46:47], v23 offset:25600
    s_waitcnt lgkmcnt(6)
    v_mfma_f32_32x32x16_bf16 v[80:95], v[60:63], v[48:51], v[80:95]
    v_mfma_f32_32x32x16_bf16 v[112:127], v[60:63], v[52:55], v[112:127]
    ds_read_b128 v[48:51], v17 offset:0
    ds_read_b64_tr_b16 v[56:57], v22 offset:28672
    s_waitcnt lgkmcnt(5)
    v_mfma_f32_32x32x16_bf16 v[64:79], v[40:43], v[32:35], v[64:79]
    ds_read_b64_tr_b16 v[58:59], v22 offset:29696
    ds_read_b128 v[52:55], v17 offset:4096
    ds_read_b64_tr_b16 v[60:61], v23 offset:28672
    s_waitcnt lgkmcnt(7)
    v_mfma_f32_32x32x16_bf16 v[96:111], v[40:43], v[36:39], v[96:111]
    ds_read_b64_tr_b16 v[62:63], v23 offset:29696
    s_waitcnt lgkmcnt(6)
    v_mfma_f32_32x32x16_bf16 v[80:95], v[44:47], v[32:35], v[80:95]
    v_mfma_f32_32x32x16_bf16 v[112:127], v[44:47], v[36:39], v[112:127]
    s_waitcnt lgkmcnt(0)
    s_barrier
    ds_read_b128 v[32:35], v14 offset:32768
    ds_read_b64_tr_b16 v[40:41], v22 offset:49152
    v_mfma_f32_32x32x16_bf16 v[64:79], v[56:59], v[48:51], v[64:79]
    ds_read_b64_tr_b16 v[42:43], v22 offset:50176
    ds_read_b128 v[36:39], v14 offset:36864
    ds_read_b64_tr_b16 v[44:45], v23 offset:49152
    v_mfma_f32_32x32x16_bf16 v[96:111], v[56:59], v[52:55], v[96:111]
    ds_read_b64_tr_b16 v[46:47], v23 offset:50176
    v_mfma_f32_32x32x16_bf16 v[80:95], v[60:63], v[48:51], v[80:95]
    v_mfma_f32_32x32x16_bf16 v[112:127], v[60:63], v[52:55], v[112:127]
    ds_read_b128 v[48:51], v15 offset:32768
    ds_read_b64_tr_b16 v[56:57], v22 offset:53248
    s_waitcnt lgkmcnt(5)
    v_mfma_f32_32x32x16_bf16 v[64:79], v[40:43], v[32:35], v[64:79]
    ds_read_b64_tr_b16 v[58:59], v22 offset:54272
    ds_read_b128 v[52:55], v15 offset:36864
    ds_read_b64_tr_b16 v[60:61], v23 offset:53248
    s_waitcnt lgkmcnt(7)
    v_mfma_f32_32x32x16_bf16 v[96:111], v[40:43], v[36:39], v[96:111]
    ds_read_b64_tr_b16 v[62:63], v23 offset:54272
    s_waitcnt lgkmcnt(6)
    v_mfma_f32_32x32x16_bf16 v[80:95], v[44:47], v[32:35], v[80:95]
    v_mfma_f32_32x32x16_bf16 v[112:127], v[44:47], v[36:39], v[112:127]
    ds_read_b128 v[32:35], v16 offset:32768
    ds_read_b64_tr_b16 v[40:41], v22 offset:57344
    s_waitcnt lgkmcnt(5)
    v_mfma_f32_32x32x16_bf16 v[64:79], v[56:59], v[48:51], v[64:79]
    ds_read_b64_tr_b16 v[42:43], v22 offset:58368
    ds_read_b128 v[36:39], v16 offset:36864
    ds_read_b64_tr_b16 v[44:45], v23 offset:57344
    s_waitcnt lgkmcnt(7)
    v_mfma_f32_32x32x16_bf16 v[96:111], v[56:59], v[52:55], v[96:111]
    ds_read_b64_tr_b16 v[46:47], v23 offset:58368
    s_waitcnt lgkmcnt(6)
    v_mfma_f32_32x32x16_bf16 v[80:95], v[60:63], v[48:51], v[80:95]
    v_mfma_f32_32x32x16_bf16 v[112:127], v[60:63], v[52:55], v[112:127]
    ds_read_b128 v[48:51], v17 offset:32768
    ds_read_b64_tr_b16 v[56:57], v22 offset:61440
    s_waitcnt lgkmcnt(5)
    v_mfma_f32_32x32x16_bf16 v[64:79], v[40:43], v[32:35], v[64:79]
    ds_read_b64_tr_b16 v[58:59], v22 offset:62464
    ds_read_b128 v[52:55], v17 offset:36864
    ds_read_b64_tr_b16 v[60:61], v23 offset:61440
    s_waitcnt lgkmcnt(7)
    v_mfma_f32_32x32x16_bf16 v[96:111], v[40:43], v[36:39], v[96:111]
    ds_read_b64_tr_b16 v[62:63], v23 offset:62464
    s_waitcnt lgkmcnt(6)
    v_mfma_f32_32x32x16_bf16 v[80:95], v[44:47], v[32:35], v[80:95]
    v_mfma_f32_32x32x16_bf16 v[112:127], v[44:47], v[36:39], v[112:127]
    s_waitcnt lgkmcnt(0)
    s_barrier
    ds_read_b128 v[32:35], v18 offset:0
    ds_read_b64_tr_b16 v[40:41], v24 offset:16384
    v_mfma_f32_32x32x16_bf16 v[64:79], v[56:59], v[48:51], v[64:79]
    ds_read_b64_tr_b16 v[42:43], v24 offset:17408
    ds_read_b128 v[36:39], v18 offset:4096
    ds_read_b64_tr_b16 v[44:45], v25 offset:16384
    v_mfma_f32_32x32x16_bf16 v[96:111], v[56:59], v[52:55], v[96:111]
    ds_read_b64_tr_b16 v[46:47], v25 offset:17408
    v_mfma_f32_32x32x16_bf16 v[80:95], v[60:63], v[48:51], v[80:95]
    v_mfma_f32_32x32x16_bf16 v[112:127], v[60:63], v[52:55], v[112:127]
    ds_read_b128 v[48:51], v19 offset:0
    ds_read_b64_tr_b16 v[56:57], v24 offset:20480
    s_waitcnt lgkmcnt(5)
    v_mfma_f32_32x32x16_bf16 v[64:79], v[40:43], v[32:35], v[64:79]
    ds_read_b64_tr_b16 v[58:59], v24 offset:21504
    ds_read_b128 v[52:55], v19 offset:4096
    ds_read_b64_tr_b16 v[60:61], v25 offset:20480
    s_waitcnt lgkmcnt(7)
    v_mfma_f32_32x32x16_bf16 v[96:111], v[40:43], v[36:39], v[96:111]
    ds_read_b64_tr_b16 v[62:63], v25 offset:21504
    s_waitcnt lgkmcnt(6)
    v_mfma_f32_32x32x16_bf16 v[80:95], v[44:47], v[32:35], v[80:95]
    v_mfma_f32_32x32x16_bf16 v[112:127], v[44:47], v[36:39], v[112:127]
    ds_read_b128 v[32:35], v20 offset:0
    ds_read_b64_tr_b16 v[40:41], v24 offset:24576
    s_waitcnt lgkmcnt(5)
    v_mfma_f32_32x32x16_bf16 v[64:79], v[56:59], v[48:51], v[64:79]
    ds_read_b64_tr_b16 v[42:43], v24 offset:25600
    ds_read_b128 v[36:39], v20 offset:4096
    ds_read_b64_tr_b16 v[44:45], v25 offset:24576
    s_waitcnt lgkmcnt(7)
    v_mfma_f32_32x32x16_bf16 v[96:111], v[56:59], v[52:55], v[96:111]
    ds_read_b64_tr_b16 v[46:47], v25 offset:25600
    s_waitcnt lgkmcnt(6)
    v_mfma_f32_32x32x16_bf16 v[80:95], v[60:63], v[48:51], v[80:95]
    v_mfma_f32_32x32x16_bf16 v[112:127], v[60:63], v[52:55], v[112:127]
    ds_read_b128 v[48:51], v21 offset:0
    ds_read_b64_tr_b16 v[56:57], v24 offset:28672
    s_waitcnt lgkmcnt(5)
    v_mfma_f32_32x32x16_bf16 v[64:79], v[40:43], v[32:35], v[64:79]
    ds_read_b64_tr_b16 v[58:59], v24 offset:29696
    ds_read_b128 v[52:55], v21 offset:4096
    ds_read_b64_tr_b16 v[60:61], v25 offset:28672
    s_waitcnt lgkmcnt(7)
    v_mfma_f32_32x32x16_bf16 v[96:111], v[40:43], v[36:39], v[96:111]
    ds_read_b64_tr_b16 v[62:63], v25 offset:29696
    s_waitcnt lgkmcnt(6)
    v_mfma_f32_32x32x16_bf16 v[80:95], v[44:47], v[32:35], v[80:95]
    v_mfma_f32_32x32x16_bf16 v[112:127], v[44:47], v[36:39], v[112:127]
    s_waitcnt lgkmcnt(0)
    s_barrier
    ds_read_b128 v[32:35], v18 offset:32768
    ds_read_b64_tr_b16 v[40:41], v24 offset:49152
    v_mfma_f32_32x32x16_bf16 v[64:79], v[56:59], v[48:51], v[64:79]
    ds_read_b64_tr_b16 v[42:43], v24 offset:50176
    ds_read_b128 v[36:39], v18 offset:36864
    ds_read_b64_tr_b16 v[44:45], v25 offset:49152
    v_mfma_f32_32x32x16_bf16 v[96:111], v[56:59], v[52:55], v[96:111]
    ds_read_b64_tr_b16 v[46:47], v25 offset:50176
    v_mfma_f32_32x32x16_bf16 v[80:95], v[60:63], v[48:51], v[80:95]
    v_mfma_f32_32x32x16_bf16 v[112:127], v[60:63], v[52:55], v[112:127]
    ds_read_b128 v[48:51], v19 offset:32768
    ds_read_b64_tr_b16 v[56:57], v24 offset:53248
    s_waitcnt lgkmcnt(5)
    v_mfma_f32_32x32x16_bf16 v[64:79], v[40:43], v[32:35], v[64:79]
    ds_read_b64_tr_b16 v[58:59], v24 offset:54272
    ds_read_b128 v[52:55], v19 offset:36864
    ds_read_b64_tr_b16 v[60:61], v25 offset:53248
    s_waitcnt lgkmcnt(7)
    v_mfma_f32_32x32x16_bf16 v[96:111], v[40:43], v[36:39], v[96:111]
    ds_read_b64_tr_b16 v[62:63], v25 offset:54272
    s_waitcnt lgkmcnt(6)
    v_mfma_f32_32x32x16_bf16 v[80:95], v[44:47], v[32:35], v[80:95]
    v_mfma_f32_32x32x16_bf16 v[112:127], v[44:47], v[36:39], v[112:127]
    ds_read_b128 v[32:35], v20 offset:32768
    ds_read_b64_tr_b16 v[40:41], v24 offset:57344
    s_waitcnt lgkmcnt(5)
    v_mfma_f32_32x32x16_bf16 v[64:79], v[56:59], v[48:51], v[64:79]
    ds_read_b64_tr_b16 v[42:43], v24 offset:58368
    ds_read_b128 v[36:39], v20 offset:36864
    ds_read_b64_tr_b16 v[44:45], v25 offset:57344
    s_waitcnt lgkmcnt(7)
    v_mfma_f32_32x32x16_bf16 v[96:111], v[56:59], v[52:55], v[96:111]
    ds_read_b64_tr_b16 v[46:47], v25 offset:58368
    s_waitcnt lgkmcnt(6)
    v_mfma_f32_32x32x16_bf16 v[80:95], v[60:63], v[48:51], v[80:95]
    v_mfma_f32_32x32x16_bf16 v[112:127], v[60:63], v[52:55], v[112:127]
    ds_read_b128 v[48:51], v21 offset:32768
    ds_read_b64_tr_b16 v[56:57], v24 offset:61440
    s_waitcnt lgkmcnt(5)
    v_mfma_f32_32x32x16_bf16 v[64:79], v[40:43], v[32:35], v[64:79]
    ds_read_b64_tr_b16 v[58:59], v24 offset:62464
    ds_read_b128 v[52:55], v21 offset:36864
    ds_read_b64_tr_b16 v[60:61], v25 offset:61440
    s_waitcnt lgkmcnt(7)
    v_mfma_f32_32x32x16_bf16 v[96:111], v[40:43], v[36:39], v[96:111]
    ds_read_b64_tr_b16 v[62:63], v25 offset:62464
    s_waitcnt lgkmcnt(6)
    v_mfma_f32_32x32x16_bf16 v[80:95], v[44:47], v[32:35], v[80:95]
    v_mfma_f32_32x32x16_bf16 v[112:127], v[44:47], v[36:39], v[112:127]
    s_waitcnt lgkmcnt(0)
    s_barrier
    s_lshl_b32 s48, s46, 7
    s_lshl_b32 s49, s47, 2
    s_add_u32 s48, s48, s49
    s_add_u32 s48, s48, 25167872
    v_mov_b32 v29, s96
    buffer_store_dword v29, v250, s[36:39], s48 offen sc1
    ds_read_b128 v[32:35], v14 offset:0
    ds_read_b64_tr_b16 v[40:41], v22 offset:16384
    v_mfma_f32_32x32x16_bf16 v[64:79], v[56:59], v[48:51], v[64:79]
    ds_read_b64_tr_b16 v[42:43], v22 offset:17408
    ds_read_b128 v[36:39], v14 offset:4096
    ds_read_b64_tr_b16 v[44:45], v23 offset:16384
    v_mfma_f32_32x32x16_bf16 v[96:111], v[56:59], v[52:55], v[96:111]
    ds_read_b64_tr_b16 v[46:47], v23 offset:17408
    v_mfma_f32_32x32x16_bf16 v[80:95], v[60:63], v[48:51], v[80:95]
    v_mfma_f32_32x32x16_bf16 v[112:127], v[60:63], v[52:55], v[112:127]
    ds_read_b128 v[48:51], v15 offset:0
    ds_read_b64_tr_b16 v[56:57], v22 offset:20480
    s_waitcnt lgkmcnt(5)
    v_mfma_f32_32x32x16_bf16 v[64:79], v[40:43], v[32:35], v[64:79]
    ds_read_b64_tr_b16 v[58:59], v22 offset:21504
    ds_read_b128 v[52:55], v15 offset:4096
    ds_read_b64_tr_b16 v[60:61], v23 offset:20480
    s_waitcnt lgkmcnt(7)
    v_mfma_f32_32x32x16_bf16 v[96:111], v[40:43], v[36:39], v[96:111]
    ds_read_b64_tr_b16 v[62:63], v23 offset:21504
    s_waitcnt lgkmcnt(6)
    v_mfma_f32_32x32x16_bf16 v[80:95], v[44:47], v[32:35], v[80:95]
    v_mfma_f32_32x32x16_bf16 v[112:127], v[44:47], v[36:39], v[112:127]
    ds_read_b128 v[32:35], v16 offset:0
    ds_read_b64_tr_b16 v[40:41], v22 offset:24576
    s_waitcnt lgkmcnt(5)
    v_mfma_f32_32x32x16_bf16 v[64:79], v[56:59], v[48:51], v[64:79]
    ds_read_b64_tr_b16 v[42:43], v22 offset:25600
    ds_read_b128 v[36:39], v16 offset:4096
    ds_read_b64_tr_b16 v[44:45], v23 offset:24576
    s_waitcnt lgkmcnt(7)
    v_mfma_f32_32x32x16_bf16 v[96:111], v[56:59], v[52:55], v[96:111]
    ds_read_b64_tr_b16 v[46:47], v23 offset:25600
    s_waitcnt lgkmcnt(6)
    v_mfma_f32_32x32x16_bf16 v[80:95], v[60:63], v[48:51], v[80:95]
    v_mfma_f32_32x32x16_bf16 v[112:127], v[60:63], v[52:55], v[112:127]
    ds_read_b128 v[48:51], v17 offset:0
    ds_read_b64_tr_b16 v[56:57], v22 offset:28672
    s_waitcnt lgkmcnt(5)
    v_mfma_f32_32x32x16_bf16 v[64:79], v[40:43], v[32:35], v[64:79]
    ds_read_b64_tr_b16 v[58:59], v22 offset:29696
    ds_read_b128 v[52:55], v17 offset:4096
    ds_read_b64_tr_b16 v[60:61], v23 offset:28672
    s_waitcnt lgkmcnt(7)
    v_mfma_f32_32x32x16_bf16 v[96:111], v[40:43], v[36:39], v[96:111]
    ds_read_b64_tr_b16 v[62:63], v23 offset:29696
    s_waitcnt lgkmcnt(6)
    v_mfma_f32_32x32x16_bf16 v[80:95], v[44:47], v[32:35], v[80:95]
    v_mfma_f32_32x32x16_bf16 v[112:127], v[44:47], v[36:39], v[112:127]
    s_waitcnt lgkmcnt(0)
    s_barrier
    v_mfma_f32_32x32x16_bf16 v[64:79], v[56:59], v[48:51], v[64:79]
    s_add_u32 m0, s68, 16384
    s_nop 0
    buffer_load_dwordx4 v10, s[64:67], s80 offen offset:0 lds
    buffer_load_dwordx4 v11, s[64:67], s80 offen offset:1024 lds
    v_mfma_f32_32x32x16_bf16 v[96:111], v[56:59], v[52:55], v[96:111]
    buffer_load_dwordx4 v12, s[64:67], s80 offen offset:2048 lds
    buffer_load_dwordx4 v13, s[64:67], s80 offen offset:3072 lds
    v_mfma_f32_32x32x16_bf16 v[80:95], v[60:63], v[48:51], v[80:95]
    v_mfma_f32_32x32x16_bf16 v[112:127], v[60:63], v[52:55], v[112:127]
    s_setprio 1
    v_lshrrev_b32 v26, 5, v1
    s_lshr_b32 s48, s90, 1
    s_lshl_b32 s48, s48, 4
    v_add_u32 v26, s48, v26
    v_lshlrev_b32 v26, 14, v26
    s_and_b32 s48, s90, 1
    s_lshl_b32 s48, s48, 9
    v_and_b32 v27, 31, v1
    v_lshl_add_u32 v26, v27, 4, v26
    v_add_u32 v26, s48, v26
    s_lshl_b32 s48, s57, 19
    s_lshl_b32 s49, s56, 10
    s_add_u32 s48, s48, s49
    s_add_u32 s48, s48, 3145728
    s_cmp_lt_u32 s57, 5
    s_cselect_b32 s50, 0x3ea52b5c, 1.0
    v_mov_b32 v30, s50
    v_pk_mul_f32 v[64:65], v[64:65], v[30:31] op_sel_hi:[1,0]
    v_pk_mul_f32 v[66:67], v[66:67], v[30:31] op_sel_hi:[1,0]
    v_pk_mul_f32 v[68:69], v[68:69], v[30:31] op_sel_hi:[1,0]
    v_pk_mul_f32 v[70:71], v[70:71], v[30:31] op_sel_hi:[1,0]
    v_pk_mul_f32 v[72:73], v[72:73], v[30:31] op_sel_hi:[1,0]
    v_pk_mul_f32 v[74:75], v[74:75], v[30:31] op_sel_hi:[1,0]
    v_pk_mul_f32 v[76:77], v[76:77], v[30:31] op_sel_hi:[1,0]
    v_pk_mul_f32 v[78:79], v[78:79], v[30:31] op_sel_hi:[1,0]
    v_pk_mul_f32 v[80:81], v[80:81], v[30:31] op_sel_hi:[1,0]
    v_pk_mul_f32 v[82:83], v[82:83], v[30:31] op_sel_hi:[1,0]
    v_pk_mul_f32 v[84:85], v[84:85], v[30:31] op_sel_hi:[1,0]
    v_pk_mul_f32 v[86:87], v[86:87], v[30:31] op_sel_hi:[1,0]
    v_pk_mul_f32 v[88:89], v[88:89], v[30:31] op_sel_hi:[1,0]
    v_pk_mul_f32 v[90:91], v[90:91], v[30:31] op_sel_hi:[1,0]
    v_pk_mul_f32 v[92:93], v[92:93], v[30:31] op_sel_hi:[1,0]
    v_pk_mul_f32 v[94:95], v[94:95], v[30:31] op_sel_hi:[1,0]
    v_pk_mul_f32 v[96:97], v[96:97], v[30:31] op_sel_hi:[1,0]
    v_pk_mul_f32 v[98:99], v[98:99], v[30:31] op_sel_hi:[1,0]
    v_pk_mul_f32 v[100:101], v[100:101], v[30:31] op_sel_hi:[1,0]
    v_pk_mul_f32 v[102:103], v[102:103], v[30:31] op_sel_hi:[1,0]
    v_pk_mul_f32 v[104:105], v[104:105], v[30:31] op_sel_hi:[1,0]
    v_pk_mul_f32 v[106:107], v[106:107], v[30:31] op_sel_hi:[1,0]
    v_pk_mul_f32 v[108:109], v[108:109], v[30:31] op_sel_hi:[1,0]
    v_pk_mul_f32 v[110:111], v[110:111], v[30:31] op_sel_hi:[1,0]
    v_pk_mul_f32 v[112:113], v[112:113], v[30:31] op_sel_hi:[1,0]
    v_pk_mul_f32 v[114:115], v[114:115], v[30:31] op_sel_hi:[1,0]
    v_pk_mul_f32 v[116:117], v[116:117], v[30:31] op_sel_hi:[1,0]
    v_pk_mul_f32 v[118:119], v[118:119], v[30:31] op_sel_hi:[1,0]
    v_pk_mul_f32 v[120:121], v[120:121], v[30:31] op_sel_hi:[1,0]
    v_pk_mul_f32 v[122:123], v[122:123], v[30:31] op_sel_hi:[1,0]
    v_pk_mul_f32 v[124:125], v[124:125], v[30:31] op_sel_hi:[1,0]
    v_pk_mul_f32 v[126:127], v[126:127], v[30:31] op_sel_hi:[1,0]
    s_add_u32 s49, s48, 0
    v_cvt_pk_bf16_f32 v32, v64, v65
    v_cvt_pk_bf16_f32 v33, v66, v67
    v_cvt_pk_bf16_f32 v34, v96, v97
    v_cvt_pk_bf16_f32 v35, v98, v99
    buffer_store_dwordx4 v[32:35], v26, s[36:39], s49 offen sc1
    s_add_u32 s49, s48, 32768
    v_cvt_pk_bf16_f32 v36, v68, v69
    v_cvt_pk_bf16_f32 v37, v70, v71
    v_cvt_pk_bf16_f32 v38, v100, v101
    v_cvt_pk_bf16_f32 v39, v102, v103
    buffer_store_dwordx4 v[36:39], v26, s[36:39], s49 offen sc1
    s_add_u32 s49, s48, 65536
    v_cvt_pk_bf16_f32 v40, v72, v73
    v_cvt_pk_bf16_f32 v41, v74, v75
    v_cvt_pk_bf16_f32 v42, v104, v105
    v_cvt_pk_bf16_f32 v43, v106, v107
    buffer_store_dwordx4 v[40:43], v26, s[36:39], s49 offen sc1
    s_add_u32 s49, s48, 98304
    v_cvt_pk_bf16_f32 v44, v76, v77
    v_cvt_pk_bf16_f32 v45, v78, v79
    v_cvt_pk_bf16_f32 v46, v108, v109
    v_cvt_pk_bf16_f32 v47, v110, v111
    buffer_store_dwordx4 v[44:47], v26, s[36:39], s49 offen sc1
    s_add_u32 s49, s48, 131072
    v_cvt_pk_bf16_f32 v48, v80, v81
    v_cvt_pk_bf16_f32 v49, v82, v83
    v_cvt_pk_bf16_f32 v50, v112, v113
    v_cvt_pk_bf16_f32 v51, v114, v115
    buffer_store_dwordx4 v[48:51], v26, s[36:39], s49 offen sc1
    s_add_u32 s49, s48, 163840
    v_cvt_pk_bf16_f32 v52, v84, v85
    v_cvt_pk_bf16_f32 v53, v86, v87
    v_cvt_pk_bf16_f32 v54, v116, v117
    v_cvt_pk_bf16_f32 v55, v118, v119
    buffer_store_dwordx4 v[52:55], v26, s[36:39], s49 offen sc1
    s_add_u32 s49, s48, 196608
    v_cvt_pk_bf16_f32 v56, v88, v89
    v_cvt_pk_bf16_f32 v57, v90, v91
    v_cvt_pk_bf16_f32 v58, v120, v121
    v_cvt_pk_bf16_f32 v59, v122, v123
    buffer_store_dwordx4 v[56:59], v26, s[36:39], s49 offen sc1
    s_add_u32 s49, s48, 229376
    v_cvt_pk_bf16_f32 v60, v92, v93
    v_cvt_pk_bf16_f32 v61, v94, v95
    v_cvt_pk_bf16_f32 v62, v124, v125
    v_cvt_pk_bf16_f32 v63, v126, v127
    buffer_store_dwordx4 v[60:63], v26, s[36:39], s49 offen sc1
    v_lshrrev_b32 v30, 4, v1
    s_sub_u32 s48, s88, 2
    v_add_u32 v30, s48, v30
    v_and_b32 v29, 15, v1
    v_cmp_le_i32 s[52:53], 0, v30
    v_cmp_gt_u32 s[50:51], 15, v29
    s_nop 0
    s_and_b64 s[52:53], s[52:53], s[50:51]
    s_mov_b32 s50, -1
    s_mov_b32 s51, 0xffff
    s_and_b64 s[52:53], s[52:53], s[50:51]
    v_lshlrev_b32 v30, 7, v30
    v_lshl_add_u32 v30, v29, 2, v30
    s_lshl_b32 s48, s88, 7
    v_mov_b32 v29, s48
    v_cndmask_b32 v30, v29, v30, s[52:53]
    v_add_u32 v30, 25168896, v30
    s_barrier
    s_add_u32 m0, s68, 32768
    s_nop 0
    buffer_load_dwordx4 v2, s[28:31], s58 offen offset:0 lds
    buffer_load_dwordx4 v3, s[28:31], s58 offen offset:1024 lds
    buffer_load_dwordx4 v4, s[28:31], s58 offen offset:2048 lds
    buffer_load_dwordx4 v5, s[28:31], s58 offen offset:3072 lds
    s_add_u32 m0, s68, 49152
    s_add_u32 s80, s80, 221184
    s_cmp_eq_u32 s80, 2211840
    s_cselect_b32 s80, 0, s80
    buffer_load_dwordx4 v10, s[64:67], s80 offen offset:0 lds
    buffer_load_dwordx4 v11, s[64:67], s80 offen offset:1024 lds
    buffer_load_dwordx4 v12, s[64:67], s80 offen offset:2048 lds
    buffer_load_dwordx4 v13, s[64:67], s80 offen offset:3072 lds
    s_barrier
    s_add_u32 m0, s68, 65536
    s_add_u32 s58, s58, 128
    s_cmp_eq_u32 s58, 1280
    s_cselect_b32 s58, 0, s58
    buffer_load_dwordx4 v2, s[28:31], s58 offen offset:0 lds
    buffer_load_dwordx4 v3, s[28:31], s58 offen offset:1024 lds
    buffer_load_dwordx4 v4, s[28:31], s58 offen offset:2048 lds
    buffer_load_dwordx4 v5, s[28:31], s58 offen offset:3072 lds
    s_add_u32 m0, s68, 81920
    s_add_u32 s80, s80, 221184
    s_cmp_eq_u32 s80, 2211840
    s_cselect_b32 s80, 0, s80
    buffer_load_dwordx4 v10, s[64:67], s80 offen offset:0 lds
    buffer_load_dwordx4 v11, s[64:67], s80 offen offset:1024 lds
    buffer_load_dwordx4 v12, s[64:67], s80 offen offset:2048 lds
    buffer_load_dwordx4 v13, s[64:67], s80 offen offset:3072 lds
    s_waitcnt vmcnt(24)
    s_barrier
    s_add_u32 m0, s68, 98304
    s_add_u32 s58, s58, 128
    s_cmp_eq_u32 s58, 1280
    s_cselect_b32 s58, 0, s58
    buffer_load_dwordx4 v2, s[28:31], s58 offen offset:0 lds
    buffer_load_dwordx4 v3, s[28:31], s58 offen offset:1024 lds
    buffer_load_dwordx4 v4, s[28:31], s58 offen offset:2048 lds
    buffer_load_dwordx4 v5, s[28:31], s58 offen offset:3072 lds
    s_add_u32 m0, s68, 114688
    s_add_u32 s80, s80, 221184
    s_cmp_eq_u32 s80, 2211840
    s_cselect_b32 s80, 0, s80
    buffer_load_dwordx4 v10, s[64:67], s80 offen offset:0 lds
    buffer_load_dwordx4 v11, s[64:67], s80 offen offset:1024 lds
    buffer_load_dwordx4 v12, s[64:67], s80 offen offset:2048 lds
    buffer_load_dwordx4 v13, s[64:67], s80 offen offset:3072 lds
    s_waitcnt vmcnt(16)
    s_barrier
    v_mov_b32 v29, s96
    buffer_store_dword v29, v250, s[36:39], s69 offen sc1
    s_add_u32 m0, s68, 0
    s_add_u32 s58, s58, 128
    s_cmp_eq_u32 s58, 1280
    s_cselect_b32 s58, 0, s58
    buffer_load_dwordx4 v2, s[28:31], s58 offen offset:0 lds
    buffer_load_dwordx4 v3, s[28:31], s58 offen offset:1024 lds
    buffer_load_dwordx4 v4, s[28:31], s58 offen offset:2048 lds
    buffer_load_dwordx4 v5, s[28:31], s58 offen offset:3072 lds
    s_add_u32 m0, s68, 16384
    s_add_u32 s80, s80, 221184
    s_cmp_eq_u32 s80, 2211840
    s_cselect_b32 s80, 0, s80
    buffer_load_dwordx4 v10, s[64:67], s80 offen offset:0 lds
    buffer_load_dwordx4 v11, s[64:67], s80 offen offset:1024 lds
    buffer_load_dwordx4 v12, s[64:67], s80 offen offset:2048 lds
    buffer_load_dwordx4 v13, s[64:67], s80 offen offset:3072 lds
    s_waitcnt vmcnt(17)
    s_barrier
    s_add_u32 m0, s68, 32768
    s_add_u32 s58, s58, 128
    s_cmp_eq_u32 s58, 1280
    s_cselect_b32 s58, 0, s58
    buffer_load_dwordx4 v2, s[28:31], s58 offen offset:0 lds
    buffer_load_dwordx4 v3, s[28:31], s58 offen offset:1024 lds
    buffer_load_dwordx4 v4, s[28:31], s58 offen offset:2048 lds
    buffer_load_dwordx4 v5, s[28:31], s58 offen offset:3072 lds
    s_add_u32 m0, s68, 49152
    s_add_u32 s80, s80, 221184
    s_cmp_eq_u32 s80, 2211840
    s_cselect_b32 s80, 0, s80
    buffer_load_dwordx4 v10, s[64:67], s80 offen offset:0 lds
    buffer_load_dwordx4 v11, s[64:67], s80 offen offset:1024 lds
    buffer_load_dwordx4 v12, s[64:67], s80 offen offset:2048 lds
    buffer_load_dwordx4 v13, s[64:67], s80 offen offset:3072 lds
    s_waitcnt vmcnt(17)
    s_barrier
    s_add_u32 m0, s68, 65536
    s_add_u32 s58, s58, 128
    s_cmp_eq_u32 s58, 1280
    s_cselect_b32 s58, 0, s58
    buffer_load_dwordx4 v2, s[28:31], s58 offen offset:0 lds
    buffer_load_dwordx4 v3, s[28:31], s58 offen offset:1024 lds
    buffer_load_dwordx4 v4, s[28:31], s58 offen offset:2048 lds
    buffer_load_dwordx4 v5, s[28:31], s58 offen offset:3072 lds
    s_add_u32 m0, s68, 81920
    s_add_u32 s80, s80, 221184
    s_cmp_eq_u32 s80, 2211840
    s_cselect_b32 s80, 0, s80
    buffer_load_dwordx4 v10, s[64:67], s80 offen offset:0 lds
    buffer_load_dwordx4 v11, s[64:67], s80 offen offset:1024 lds
    buffer_load_dwordx4 v12, s[64:67], s80 offen offset:2048 lds
    buffer_load_dwordx4 v13, s[64:67], s80 offen offset:3072 lds
    s_lshl_b32 s48, s56, 7
    s_add_u32 s48, s48, 25165824
    v_mov_b32 v26, s48
    s_min_u32 s49, s57, 13
    s_lshl_b32 s49, s49, 2
    s_add_u32 s49, s49, 25175040
    v_mov_b32 v27, s49
    v_cmp_gt_u32 s[52:53], 32, v1
    s_nop 1
    v_cndmask_b32 v234, v27, v26, s[52:53]
    buffer_load_dword v235, v234, s[36:39], 0 offen sc1
    s_waitcnt vmcnt(17)
    s_barrier
    s_waitcnt vmcnt(9)
    s_barrier
    s_cmp_ge_u32 s57, 14
    s_cbranch_scc1 nf_6
    s_waitcnt vmcnt(0)
    v_cmp_ne_u32 vcc, s96, v235
    s_nop 4
    s_cbranch_vccz pc_7_ok
pc_7:
    s_sleep 1
    buffer_load_dword v235, v234, s[36:39], 0 offen sc1
    s_waitcnt vmcnt(0)
    v_cmp_ne_u32 vcc, s96, v235
    s_nop 4
    s_cbranch_vccnz pc_7
pc_7_ok:
nf_6:
    s_lshl_b32 s48, s56, 10
    s_add_u32 s48, s48, 0
    s_lshl_b32 s49, s57, 9
    s_add_u32 s50, s49, 65536
    s_add_u32 s49, s49, 73728
    s_cmp_eq_u32 s44, 1
    s_cselect_b32 s48, s50, s48
    s_cselect_b32 s51, 1024, 0
    s_cmp_eq_u32 s44, 2
    s_cselect_b32 s48, s49, s48
    s_cselect_b32 s51, 1536, s51
    s_cmp_eq_u32 s44, 3
    s_cselect_b32 s48, 0x7fff0000, s48
    s_cselect_b32 s51, 2048, s51
    v_lshlrev_b32 v26, 4, v1
    v_mov_b32 v27, 0x7ffffff0
    s_cmp_eq_u32 s44, 0
    s_cselect_b32 s49, 64, 32
    v_cmp_gt_u32 s[52:53], s49, v1
    s_nop 0
    s_mov_b64 exec, s[52:53]
    s_mov_b32 m0, s51
    s_nop 0
    buffer_load_dwordx4 v26, s[36:39], s48 offen sc1 lds
    s_mov_b64 exec, -1
    s_waitcnt vmcnt(2)
    s_barrier
    buffer_load_dword v31, v30, s[36:39], 0 offen sc1
    v_and_b32 v232, 31, v1
    v_lshlrev_b32 v232, 2, v232
    s_lshl_b32 s49, s74, 7
    s_add_u32 s49, s49, 25167872
    v_add_u32 v232, s49, v232
    buffer_load_dword v233, v232, s[36:39], 0 offen sc1
    s_waitcnt vmcnt(2)
    s_barrier
    s_waitcnt vmcnt(1)
    v_cmp_ne_u32 vcc, s96, v31
    s_nop 4
    s_cbranch_vccz pc_8_ok
pc_8:
    s_sleep 1
    buffer_load_dword v31, v30, s[36:39], 0 offen sc1
    s_waitcnt vmcnt(0)
    v_cmp_ne_u32 vcc, s96, v31
    s_nop 4
    s_cbranch_vccnz pc_8
pc_8_ok:
    v_lshlrev_b32 v3, 4, v1
    s_mul_i32 s50, s89, 163840
    s_lshl_b32 s48, s88, 10
    s_add_u32 s50, s50, s48
    s_add_u32 s50, s50, 3145728
    s_add_u32 s48, s44, 0
    s_lshl_b32 s49, s48, 14
    s_add_u32 s49, s49, s50
    s_lshl_b32 s51, s48, 10
    s_add_u32 s51, s51, 81920
    s_mov_b32 m0, s51
    s_nop 0
    buffer_load_dwordx4 v3, s[36:39], s49 offen sc1 lds
    s_add_u32 s48, s44, 4
    s_lshl_b32 s49, s48, 14
    s_add_u32 s49, s49, s50
    s_lshl_b32 s51, s48, 10
    s_add_u32 s51, s51, 81920
    s_mov_b32 m0, s51
    s_nop 0
    buffer_load_dwordx4 v3, s[36:39], s49 offen sc1 lds
    s_add_u32 s48, s44, 8
    s_lshl_b32 s49, s48, 14
    s_add_u32 s49, s49, s50
    s_lshl_b32 s51, s48, 10
    s_add_u32 s51, s51, 81920
    s_cmp_lt_u32 s48, 10
    s_cselect_b32 s49, s49, 0x7fff0000
    s_mov_b32 m0, s51
    s_nop 0
    buffer_load_dwordx4 v3, s[36:39], s49 offen sc1 lds
    s_sub_u32 s48, s88, 2
    s_lshl_b32 s48, s48, 7
    s_mul_i32 s49, s44, 96
    s_add_u32 s48, s48, s49
    v_lshlrev_b32 v26, 1, v1
    v_add_u32 v26, s48, v26
    v_lshlrev_b32 v27, 3, v26
    v_mov_b32 v28, 0x7ffffff0
    v_cmp_le_i32 s[52:53], 0, v26
    s_nop 1
    v_cndmask_b32 v2, v28, v27, s[52:53]
    s_mul_i32 s50, s89, 163840
    s_add_u32 s50, s50, 5767168
    s_mul_i32 s51, s44, 768
    s_mov_b32 exec_hi, 0xffff
    s_add_u32 m0, s51, 98304
    s_add_u32 s54, s50, 0
    buffer_load_dwordx4 v2, s[36:39], s54 offen sc1 lds
    s_add_u32 m0, s51, 101408
    s_add_u32 s54, s50, 16384
    buffer_load_dwordx4 v2, s[36:39], s54 offen sc1 lds
    s_add_u32 m0, s51, 104512
    s_add_u32 s54, s50, 32768
    buffer_load_dwordx4 v2, s[36:39], s54 offen sc1 lds
    s_add_u32 m0, s51, 107616
    s_add_u32 s54, s50, 49152
    buffer_load_dwordx4 v2, s[36:39], s54 offen sc1 lds
    s_add_u32 m0, s51, 110720
    s_add_u32 s54, s50, 65536
    buffer_load_dwordx4 v2, s[36:39], s54 offen sc1 lds
    s_add_u32 m0, s51, 113824
    s_add_u32 s54, s50, 81920
    buffer_load_dwordx4 v2, s[36:39], s54 offen sc1 lds
    s_add_u32 m0, s51, 116928
    s_add_u32 s54, s50, 98304
    buffer_load_dwordx4 v2, s[36:39], s54 offen sc1 lds
    s_add_u32 m0, s51, 120032
    s_add_u32 s54, s50, 114688
    buffer_load_dwordx4 v2, s[36:39], s54 offen sc1 lds
    s_add_u32 m0, s51, 123136
    s_add_u32 s54, s50, 131072
    buffer_load_dwordx4 v2, s[36:39], s54 offen sc1 lds
    s_add_u32 m0, s51, 126240
    s_add_u32 s54, s50, 147456
    buffer_load_dwordx4 v2, s[36:39], s54 offen sc1 lds
    s_add_u32 m0, s51, 129344
    s_add_u32 s54, s50, 2621440
    buffer_load_dwordx4 v2, s[36:39], s54 offen sc1 lds
    s_add_u32 m0, s51, 132448
    s_add_u32 s54, s50, 2637824
    buffer_load_dwordx4 v2, s[36:39], s54 offen sc1 lds
    s_add_u32 m0, s51, 135552
    s_add_u32 s54, s50, 2654208
    buffer_load_dwordx4 v2, s[36:39], s54 offen sc1 lds
    s_add_u32 m0, s51, 138656
    s_add_u32 s54, s50, 2670592
    buffer_load_dwordx4 v2, s[36:39], s54 offen sc1 lds
    s_add_u32 m0, s51, 141760
    s_add_u32 s54, s50, 2686976
    buffer_load_dwordx4 v2, s[36:39], s54 offen sc1 lds
    s_add_u32 m0, s51, 144864
    s_add_u32 s54, s50, 2703360
    buffer_load_dwordx4 v2, s[36:39], s54 offen sc1 lds
    s_add_u32 m0, s51, 147968
    s_add_u32 s54, s50, 2719744
    buffer_load_dwordx4 v2, s[36:39], s54 offen sc1 lds
    s_add_u32 m0, s51, 151072
    s_add_u32 s54, s50, 2736128
    buffer_load_dwordx4 v2, s[36:39], s54 offen sc1 lds
    s_add_u32 m0, s51, 154176
    s_add_u32 s54, s50, 2752512
    buffer_load_dwordx4 v2, s[36:39], s54 offen sc1 lds
    s_add_u32 m0, s51, 157280
    s_add_u32 s54, s50, 2768896
    buffer_load_dwordx4 v2, s[36:39], s54 offen sc1 lds
    s_mov_b32 exec_hi, -1
    s_waitcnt vmcnt(23)
    v_cmp_ne_u32 vcc, s96, v233
    s_nop 4
    s_cbranch_vccz pc_9_ok
pc_9:
    s_sleep 1
    buffer_load_dword v233, v232, s[36:39], 0 offen sc1
    s_waitcnt vmcnt(0)
    v_cmp_ne_u32 vcc, s96, v233
    s_nop 4
    s_cbranch_vccnz pc_9
pc_9_ok:
    s_waitcnt vmcnt(10)
    s_branch s1_join
s1_idle:
    s_waitcnt lgkmcnt(0)
    s_mov_b32 s36, s26
    s_and_b32 s37, s27, 0xffff
    s_mov_b32 s38, 27262976
    s_mov_b32 s39, 0x20000
    v_mov_b32 v250, 0x7ffffff0
    v_cmp_eq_u32 s[52:53], 0, v0
    s_nop 1
    v_cndmask_b32 v250, v250, 0, s[52:53]
    s_or_b32 s48, s2, s44
    s_cmp_lg_u32 s48, 0
    s_cbranch_scc1 np_10
    s_memrealtime s[52:53]
    s_waitcnt lgkmcnt(0)
    s_or_b32 s52, s52, 1
    v_mov_b32 v248, s52
    v_mov_b32 v249, 0
    s_mov_b64 exec, 1
    global_store_dword v249, v248, s[24:25] sc1
    s_mov_b64 exec, -1
np_10:
    s_lshl_b32 s48, s46, 1
    s_and_b32 s49, s47, 1
    s_add_u32 s89, s48, s49
    s_lshr_b32 s88, s47, 1
    s_lshr_b32 s78, s44, 2
    s_and_b32 s79, s44, 3
    s_lshr_b32 s48, s46, 1
    s_lshl_b32 s48, s48, 3
    s_and_b32 s49, s47, 7
    s_add_u32 s73, s48, s49
    s_and_b32 s48, s46, 1
    s_lshl_b32 s48, s48, 2
    s_lshr_b32 s49, s47, 3
    s_add_u32 s74, s48, s49
    s_mul_i32 s75, s44, 5120
    s_mul_i32 s48, s74, 378880
    s_add_u32 s48, s48, s75
    s_add_u32 s76, s48, 22020096
    s_mov_b32 s28, s4
    s_and_b32 s29, s5, 0xffff
    s_mov_b32 s30, 2621440
    s_mov_b32 s31, 0x20000
    s_mov_b32 s60, s20
    s_and_b32 s61, s21, 0xffff
    s_mov_b32 s62, 1280
    s_mov_b32 s63, 0x20000
    s_lshl_b32 s48, s56, 7
    s_lshl_b32 s49, s44, 4
    s_add_u32 s85, s48, s49
    v_lshrrev_b32 v98, 4, v1
    v_add_u32 v98, s85, v98
    s_movk_i32 s49, 1280
    v_mul_lo_u32 v96, v98, s49
    v_and_b32 v97, 15, v1
    v_lshlrev_b32 v97, 4, v97
    v_add_u32 v96, v96, v97
    buffer_load_dwordx4 v[108:111], v97, s[60:63], 0 offen offset:0
    buffer_load_dwordx4 v[112:115], v97, s[60:63], 0 offen offset:256
    buffer_load_dwordx4 v[116:119], v97, s[60:63], 0 offen offset:512
    buffer_load_dwordx4 v[120:123], v97, s[60:63], 0 offen offset:768
    buffer_load_dwordx4 v[124:127], v97, s[60:63], 0 offen offset:1024
    s_movk_i32 s50, 0
    buffer_load_dwordx4 v[128:131], v96, s[28:31], s50 offen offset:0
    buffer_load_dwordx4 v[132:135], v96, s[28:31], s50 offen offset:256
    buffer_load_dwordx4 v[136:139], v96, s[28:31], s50 offen offset:512
    buffer_load_dwordx4 v[140:143], v96, s[28:31], s50 offen offset:768
    buffer_load_dwordx4 v[144:147], v96, s[28:31], s50 offen offset:1024
    s_movk_i32 s50, 5120
    buffer_load_dwordx4 v[148:151], v96, s[28:31], s50 offen offset:0
    buffer_load_dwordx4 v[152:155], v96, s[28:31], s50 offen offset:256
    buffer_load_dwordx4 v[156:159], v96, s[28:31], s50 offen offset:512
    buffer_load_dwordx4 v[160:163], v96, s[28:31], s50 offen offset:768
    buffer_load_dwordx4 v[164:167], v96, s[28:31], s50 offen offset:1024
    s_movk_i32 s50, 10240
    buffer_load_dwordx4 v[168:171], v96, s[28:31], s50 offen offset:0
    buffer_load_dwordx4 v[172:175], v96, s[28:31], s50 offen offset:256
    buffer_load_dwordx4 v[176:179], v96, s[28:31], s50 offen offset:512
    buffer_load_dwordx4 v[180:183], v96, s[28:31], s50 offen offset:768
    buffer_load_dwordx4 v[184:187], v96, s[28:31], s50 offen offset:1024
    s_movk_i32 s50, 15360
    buffer_load_dwordx4 v[188:191], v96, s[28:31], s50 offen offset:0
    buffer_load_dwordx4 v[192:195], v96, s[28:31], s50 offen offset:256
    buffer_load_dwordx4 v[196:199], v96, s[28:31], s50 offen offset:512
    buffer_load_dwordx4 v[200:203], v96, s[28:31], s50 offen offset:768
    buffer_load_dwordx4 v[204:207], v96, s[28:31], s50 offen offset:1024
    s_mov_b32 s32, s12
    s_and_b32 s33, s13, 0xffff
    s_mov_b32 s34, 2211840
    s_mov_b32 s35, 0x20000
    v_lshrrev_b32 v2, 4, v0
    s_movk_i32 s48, 3456
    v_mul_lo_u32 v2, v2, s48
    v_and_b32 v3, 15, v0
    v_lshl_add_u32 v2, v3, 4, v2
    s_lshl_b32 s49, s56, 8
    v_add_u32 v5, s49, v2
    s_cmp_lt_u32 s56, 14
    s_cselect_b32 s51, 0, 0x7fff0000
    s_add_u32 s50, s51, 0
    buffer_load_dwordx4 v[16:19], v5, s[32:35], s50 offen
    s_add_u32 s50, s51, 110592
    buffer_load_dwordx4 v[20:23], v5, s[32:35], s50 offen
    s_add_u32 s50, s51, 221184
    buffer_load_dwordx4 v[24:27], v5, s[32:35], s50 offen
    s_add_u32 s50, s51, 331776
    buffer_load_dwordx4 v[28:31], v5, s[32:35], s50 offen
    s_add_u32 s50, s51, 442368
    buffer_load_dwordx4 v[32:35], v5, s[32:35], s50 offen
    s_add_u32 s50, s51, 552960
    buffer_load_dwordx4 v[36:39], v5, s[32:35], s50 offen
    s_add_u32 s50, s51, 663552
    buffer_load_dwordx4 v[40:43], v5, s[32:35], s50 offen
    s_add_u32 s50, s51, 774144
    buffer_load_dwordx4 v[44:47], v5, s[32:35], s50 offen
    s_add_u32 s50, s51, 884736
    buffer_load_dwordx4 v[48:51], v5, s[32:35], s50 offen
    s_add_u32 s50, s51, 995328
    buffer_load_dwordx4 v[52:55], v5, s[32:35], s50 offen
    s_add_u32 s50, s51, 1105920
    buffer_load_dwordx4 v[56:59], v5, s[32:35], s50 offen
    s_add_u32 s50, s51, 1216512
    buffer_load_dwordx4 v[60:63], v5, s[32:35], s50 offen
    s_add_u32 s50, s51, 1327104
    buffer_load_dwordx4 v[64:67], v5, s[32:35], s50 offen
    s_add_u32 s50, s51, 1437696
    buffer_load_dwordx4 v[68:71], v5, s[32:35], s50 offen
    s_add_u32 s50, s51, 1548288
    buffer_load_dwordx4 v[72:75], v5, s[32:35], s50 offen
    s_add_u32 s50, s51, 1658880
    buffer_load_dwordx4 v[76:79], v5, s[32:35], s50 offen
    s_add_u32 s50, s51, 1769472
    buffer_load_dwordx4 v[80:83], v5, s[32:35], s50 offen
    s_add_u32 s50, s51, 1880064
    buffer_load_dwordx4 v[84:87], v5, s[32:35], s50 offen
    s_add_u32 s50, s51, 1990656
    buffer_load_dwordx4 v[88:91], v5, s[32:35], s50 offen
    s_add_u32 s50, s51, 2101248
    buffer_load_dwordx4 v[92:95], v5, s[32:35], s50 offen
    v_mov_b32 v253, 0
    global_load_dword v252, v253, s[24:25] sc1
    v_mov_b32 v101, 0x3f803f80
    v_and_b32 v104, 15, v1
    s_waitcnt vmcnt(36)
    v_mov_b32 v98, 0
    v_mov_b32 v99, 0
    v_mov_b32 v100, 0
    v_dot2c_f32_bf16 v98, v128, v101
    v_dot2c_f32_bf16 v99, v128, v128
    v_dot2c_f32_bf16 v100, v128, v108
    v_dot2c_f32_bf16 v98, v129, v101
    v_dot2c_f32_bf16 v99, v129, v129
    v_dot2c_f32_bf16 v100, v129, v109
    v_dot2c_f32_bf16 v98, v130, v101
    v_dot2c_f32_bf16 v99, v130, v130
    v_dot2c_f32_bf16 v100, v130, v110
    v_dot2c_f32_bf16 v98, v131, v101
    v_dot2c_f32_bf16 v99, v131, v131
    v_dot2c_f32_bf16 v100, v131, v111
    v_dot2c_f32_bf16 v98, v132, v101
    v_dot2c_f32_bf16 v99, v132, v132
    v_dot2c_f32_bf16 v100, v132, v112
    v_dot2c_f32_bf16 v98, v133, v101
    v_dot2c_f32_bf16 v99, v133, v133
    v_dot2c_f32_bf16 v100, v133, v113
    v_dot2c_f32_bf16 v98, v134, v101
    v_dot2c_f32_bf16 v99, v134, v134
    v_dot2c_f32_bf16 v100, v134, v114
    v_dot2c_f32_bf16 v98, v135, v101
    v_dot2c_f32_bf16 v99, v135, v135
    v_dot2c_f32_bf16 v100, v135, v115
    v_dot2c_f32_bf16 v98, v136, v101
    v_dot2c_f32_bf16 v99, v136, v136
    v_dot2c_f32_bf16 v100, v136, v116
    v_dot2c_f32_bf16 v98, v137, v101
    v_dot2c_f32_bf16 v99, v137, v137
    v_dot2c_f32_bf16 v100, v137, v117
    v_dot2c_f32_bf16 v98, v138, v101
    v_dot2c_f32_bf16 v99, v138, v138
    v_dot2c_f32_bf16 v100, v138, v118
    v_dot2c_f32_bf16 v98, v139, v101
    v_dot2c_f32_bf16 v99, v139, v139
    v_dot2c_f32_bf16 v100, v139, v119
    v_dot2c_f32_bf16 v98, v140, v101
    v_dot2c_f32_bf16 v99, v140, v140
    v_dot2c_f32_bf16 v100, v140, v120
    v_dot2c_f32_bf16 v98, v141, v101
    v_dot2c_f32_bf16 v99, v141, v141
    v_dot2c_f32_bf16 v100, v141, v121
    v_dot2c_f32_bf16 v98, v142, v101
    v_dot2c_f32_bf16 v99, v142, v142
    v_dot2c_f32_bf16 v100, v142, v122
    v_dot2c_f32_bf16 v98, v143, v101
    v_dot2c_f32_bf16 v99, v143, v143
    v_dot2c_f32_bf16 v100, v143, v123
    v_dot2c_f32_bf16 v98, v144, v101
    v_dot2c_f32_bf16 v99, v144, v144
    v_dot2c_f32_bf16 v100, v144, v124
    v_dot2c_f32_bf16 v98, v145, v101
    v_dot2c_f32_bf16 v99, v145, v145
    v_dot2c_f32_bf16 v100, v145, v125
    v_dot2c_f32_bf16 v98, v146, v101
    v_dot2c_f32_bf16 v99, v146, v146
    v_dot2c_f32_bf16 v100, v146, v126
    v_dot2c_f32_bf16 v98, v147, v101
    v_dot2c_f32_bf16 v99, v147, v147
    v_dot2c_f32_bf16 v100, v147, v127
    s_nop 0
    v_add_f32_dpp v98, v98, v98 row_ror:8 row_mask:0xf bank_mask:0xf
    v_add_f32_dpp v99, v99, v99 row_ror:8 row_mask:0xf bank_mask:0xf
    v_add_f32_dpp v100, v100, v100 row_ror:8 row_mask:0xf bank_mask:0xf
    v_add_f32_dpp v98, v98, v98 row_ror:4 row_mask:0xf bank_mask:0xf
    v_add_f32_dpp v99, v99, v99 row_ror:4 row_mask:0xf bank_mask:0xf
    v_add_f32_dpp v100, v100, v100 row_ror:4 row_mask:0xf bank_mask:0xf
    v_add_f32_dpp v98, v98, v98 row_ror:2 row_mask:0xf bank_mask:0xf
    v_add_f32_dpp v99, v99, v99 row_ror:2 row_mask:0xf bank_mask:0xf
    v_add_f32_dpp v100, v100, v100 row_ror:2 row_mask:0xf bank_mask:0xf
    v_add_f32_dpp v98, v98, v98 row_ror:1 row_mask:0xf bank_mask:0xf
    v_add_f32_dpp v99, v99, v99 row_ror:1 row_mask:0xf bank_mask:0xf
    v_add_f32_dpp v100, v100, v100 row_ror:1 row_mask:0xf bank_mask:0xf
    v_mul_f32 v98, 0x3acccccd, v98
    v_mul_f32 v99, 0x3acccccd, v99
    v_mul_f32 v100, 0xbfb8aa3b, v100
    v_fma_f32 v99, -v98, v98, v99
    v_exp_f32 v100, v100
    v_max_f32 v99, 0, v99
    v_add_f32 v99, 0x3727c5ac, v99
    v_add_f32 v100, 1.0, v100
    v_rsq_f32 v103, v99
    v_rcp_f32 v100, v100
    v_mul_f32 v102, v98, v103
    v_sub_f32 v102, 0, v102
    v_cmp_eq_u32 s[52:53], 0, v104
    s_nop 1
    v_cndmask_b32 v106, v106, v102, s[52:53]
    v_cndmask_b32 v107, v107, v103, s[52:53]
    v_cndmask_b32 v105, v105, v100, s[52:53]
    s_waitcnt vmcnt(31)
    v_mov_b32 v98, 0
    v_mov_b32 v99, 0
    v_mov_b32 v100, 0
    v_dot2c_f32_bf16 v98, v148, v101
    v_dot2c_f32_bf16 v99, v148, v148
    v_dot2c_f32_bf16 v100, v148, v108
    v_dot2c_f32_bf16 v98, v149, v101
    v_dot2c_f32_bf16 v99, v149, v149
    v_dot2c_f32_bf16 v100, v149, v109
    v_dot2c_f32_bf16 v98, v150, v101
    v_dot2c_f32_bf16 v99, v150, v150
    v_dot2c_f32_bf16 v100, v150, v110
    v_dot2c_f32_bf16 v98, v151, v101
    v_dot2c_f32_bf16 v99, v151, v151
    v_dot2c_f32_bf16 v100, v151, v111
    v_dot2c_f32_bf16 v98, v152, v101
    v_dot2c_f32_bf16 v99, v152, v152
    v_dot2c_f32_bf16 v100, v152, v112
    v_dot2c_f32_bf16 v98, v153, v101
    v_dot2c_f32_bf16 v99, v153, v153
    v_dot2c_f32_bf16 v100, v153, v113
    v_dot2c_f32_bf16 v98, v154, v101
    v_dot2c_f32_bf16 v99, v154, v154
    v_dot2c_f32_bf16 v100, v154, v114
    v_dot2c_f32_bf16 v98, v155, v101
    v_dot2c_f32_bf16 v99, v155, v155
    v_dot2c_f32_bf16 v100, v155, v115
    v_dot2c_f32_bf16 v98, v156, v101
    v_dot2c_f32_bf16 v99, v156, v156
    v_dot2c_f32_bf16 v100, v156, v116
    v_dot2c_f32_bf16 v98, v157, v101
    v_dot2c_f32_bf16 v99, v157, v157
    v_dot2c_f32_bf16 v100, v157, v117
    v_dot2c_f32_bf16 v98, v158, v101
    v_dot2c_f32_bf16 v99, v158, v158
    v_dot2c_f32_bf16 v100, v158, v118
    v_dot2c_f32_bf16 v98, v159, v101
    v_dot2c_f32_bf16 v99, v159, v159
    v_dot2c_f32_bf16 v100, v159, v119
    v_dot2c_f32_bf16 v98, v160, v101
    v_dot2c_f32_bf16 v99, v160, v160
    v_dot2c_f32_bf16 v100, v160, v120
    v_dot2c_f32_bf16 v98, v161, v101
    v_dot2c_f32_bf16 v99, v161, v161
    v_dot2c_f32_bf16 v100, v161, v121
    v_dot2c_f32_bf16 v98, v162, v101
    v_dot2c_f32_bf16 v99, v162, v162
    v_dot2c_f32_bf16 v100, v162, v122
    v_dot2c_f32_bf16 v98, v163, v101
    v_dot2c_f32_bf16 v99, v163, v163
    v_dot2c_f32_bf16 v100, v163, v123
    v_dot2c_f32_bf16 v98, v164, v101
    v_dot2c_f32_bf16 v99, v164, v164
    v_dot2c_f32_bf16 v100, v164, v124
    v_dot2c_f32_bf16 v98, v165, v101
    v_dot2c_f32_bf16 v99, v165, v165
    v_dot2c_f32_bf16 v100, v165, v125
    v_dot2c_f32_bf16 v98, v166, v101
    v_dot2c_f32_bf16 v99, v166, v166
    v_dot2c_f32_bf16 v100, v166, v126
    v_dot2c_f32_bf16 v98, v167, v101
    v_dot2c_f32_bf16 v99, v167, v167
    v_dot2c_f32_bf16 v100, v167, v127
    s_nop 0
    v_add_f32_dpp v98, v98, v98 row_ror:8 row_mask:0xf bank_mask:0xf
    v_add_f32_dpp v99, v99, v99 row_ror:8 row_mask:0xf bank_mask:0xf
    v_add_f32_dpp v100, v100, v100 row_ror:8 row_mask:0xf bank_mask:0xf
    v_add_f32_dpp v98, v98, v98 row_ror:4 row_mask:0xf bank_mask:0xf
    v_add_f32_dpp v99, v99, v99 row_ror:4 row_mask:0xf bank_mask:0xf
    v_add_f32_dpp v100, v100, v100 row_ror:4 row_mask:0xf bank_mask:0xf
    v_add_f32_dpp v98, v98, v98 row_ror:2 row_mask:0xf bank_mask:0xf
    v_add_f32_dpp v99, v99, v99 row_ror:2 row_mask:0xf bank_mask:0xf
    v_add_f32_dpp v100, v100, v100 row_ror:2 row_mask:0xf bank_mask:0xf
    v_add_f32_dpp v98, v98, v98 row_ror:1 row_mask:0xf bank_mask:0xf
    v_add_f32_dpp v99, v99, v99 row_ror:1 row_mask:0xf bank_mask:0xf
    v_add_f32_dpp v100, v100, v100 row_ror:1 row_mask:0xf bank_mask:0xf
    v_mul_f32 v98, 0x3acccccd, v98
    v_mul_f32 v99, 0x3acccccd, v99
    v_mul_f32 v100, 0xbfb8aa3b, v100
    v_fma_f32 v99, -v98, v98, v99
    v_exp_f32 v100, v100
    v_max_f32 v99, 0, v99
    v_add_f32 v99, 0x3727c5ac, v99
    v_add_f32 v100, 1.0, v100
    v_rsq_f32 v103, v99
    v_rcp_f32 v100, v100
    v_mul_f32 v102, v98, v103
    v_sub_f32 v102, 0, v102
    v_cmp_eq_u32 s[52:53], 1, v104
    s_nop 1
    v_cndmask_b32 v106, v106, v102, s[52:53]
    v_cndmask_b32 v107, v107, v103, s[52:53]
    v_cndmask_b32 v105, v105, v100, s[52:53]
    s_waitcnt vmcnt(26)
    v_mov_b32 v98, 0
    v_mov_b32 v99, 0
    v_mov_b32 v100, 0
    v_dot2c_f32_bf16 v98, v168, v101
    v_dot2c_f32_bf16 v99, v168, v168
    v_dot2c_f32_bf16 v100, v168, v108
    v_dot2c_f32_bf16 v98, v169, v101
    v_dot2c_f32_bf16 v99, v169, v169
    v_dot2c_f32_bf16 v100, v169, v109
    v_dot2c_f32_bf16 v98, v170, v101
    v_dot2c_f32_bf16 v99, v170, v170
    v_dot2c_f32_bf16 v100, v170, v110
    v_dot2c_f32_bf16 v98, v171, v101
    v_dot2c_f32_bf16 v99, v171, v171
    v_dot2c_f32_bf16 v100, v171, v111
    v_dot2c_f32_bf16 v98, v172, v101
    v_dot2c_f32_bf16 v99, v172, v172
    v_dot2c_f32_bf16 v100, v172, v112
    v_dot2c_f32_bf16 v98, v173, v101
    v_dot2c_f32_bf16 v99, v173, v173
    v_dot2c_f32_bf16 v100, v173, v113
    v_dot2c_f32_bf16 v98, v174, v101
    v_dot2c_f32_bf16 v99, v174, v174
    v_dot2c_f32_bf16 v100, v174, v114
    v_dot2c_f32_bf16 v98, v175, v101
    v_dot2c_f32_bf16 v99, v175, v175
    v_dot2c_f32_bf16 v100, v175, v115
    v_dot2c_f32_bf16 v98, v176, v101
    v_dot2c_f32_bf16 v99, v176, v176
    v_dot2c_f32_bf16 v100, v176, v116
    v_dot2c_f32_bf16 v98, v177, v101
    v_dot2c_f32_bf16 v99, v177, v177
    v_dot2c_f32_bf16 v100, v177, v117
    v_dot2c_f32_bf16 v98, v178, v101
    v_dot2c_f32_bf16 v99, v178, v178
    v_dot2c_f32_bf16 v100, v178, v118
    v_dot2c_f32_bf16 v98, v179, v101
    v_dot2c_f32_bf16 v99, v179, v179
    v_dot2c_f32_bf16 v100, v179, v119
    v_dot2c_f32_bf16 v98, v180, v101
    v_dot2c_f32_bf16 v99, v180, v180
    v_dot2c_f32_bf16 v100, v180, v120
    v_dot2c_f32_bf16 v98, v181, v101
    v_dot2c_f32_bf16 v99, v181, v181
    v_dot2c_f32_bf16 v100, v181, v121
    v_dot2c_f32_bf16 v98, v182, v101
    v_dot2c_f32_bf16 v99, v182, v182
    v_dot2c_f32_bf16 v100, v182, v122
    v_dot2c_f32_bf16 v98, v183, v101
    v_dot2c_f32_bf16 v99, v183, v183
    v_dot2c_f32_bf16 v100, v183, v123
    v_dot2c_f32_bf16 v98, v184, v101
    v_dot2c_f32_bf16 v99, v184, v184
    v_dot2c_f32_bf16 v100, v184, v124
    v_dot2c_f32_bf16 v98, v185, v101
    v_dot2c_f32_bf16 v99, v185, v185
    v_dot2c_f32_bf16 v100, v185, v125
    v_dot2c_f32_bf16 v98, v186, v101
    v_dot2c_f32_bf16 v99, v186, v186
    v_dot2c_f32_bf16 v100, v186, v126
    v_dot2c_f32_bf16 v98, v187, v101
    v_dot2c_f32_bf16 v99, v187, v187
    v_dot2c_f32_bf16 v100, v187, v127
    s_nop 0
    v_add_f32_dpp v98, v98, v98 row_ror:8 row_mask:0xf bank_mask:0xf
    v_add_f32_dpp v99, v99, v99 row_ror:8 row_mask:0xf bank_mask:0xf
    v_add_f32_dpp v100, v100, v100 row_ror:8 row_mask:0xf bank_mask:0xf
    v_add_f32_dpp v98, v98, v98 row_ror:4 row_mask:0xf bank_mask:0xf
    v_add_f32_dpp v99, v99, v99 row_ror:4 row_mask:0xf bank_mask:0xf
    v_add_f32_dpp v100, v100, v100 row_ror:4 row_mask:0xf bank_mask:0xf
    v_add_f32_dpp v98, v98, v98 row_ror:2 row_mask:0xf bank_mask:0xf
    v_add_f32_dpp v99, v99, v99 row_ror:2 row_mask:0xf bank_mask:0xf
    v_add_f32_dpp v100, v100, v100 row_ror:2 row_mask:0xf bank_mask:0xf
    v_add_f32_dpp v98, v98, v98 row_ror:1 row_mask:0xf bank_mask:0xf
    v_add_f32_dpp v99, v99, v99 row_ror:1 row_mask:0xf bank_mask:0xf
    v_add_f32_dpp v100, v100, v100 row_ror:1 row_mask:0xf bank_mask:0xf
    v_mul_f32 v98, 0x3acccccd, v98
    v_mul_f32 v99, 0x3acccccd, v99
    v_mul_f32 v100, 0xbfb8aa3b, v100
    v_fma_f32 v99, -v98, v98, v99
    v_exp_f32 v100, v100
    v_max_f32 v99, 0, v99
    v_add_f32 v99, 0x3727c5ac, v99
    v_add_f32 v100, 1.0, v100
    v_rsq_f32 v103, v99
    v_rcp_f32 v100, v100
    v_mul_f32 v102, v98, v103
    v_sub_f32 v102, 0, v102
    v_cmp_eq_u32 s[52:53], 2, v104
    s_nop 1
    v_cndmask_b32 v106, v106, v102, s[52:53]
    v_cndmask_b32 v107, v107, v103, s[52:53]
    v_cndmask_b32 v105, v105, v100, s[52:53]
    s_waitcnt vmcnt(21)
    v_mov_b32 v98, 0
    v_mov_b32 v99, 0
    v_mov_b32 v100, 0
    v_dot2c_f32_bf16 v98, v188, v101
    v_dot2c_f32_bf16 v99, v188, v188
    v_dot2c_f32_bf16 v100, v188, v108
    v_dot2c_f32_bf16 v98, v189, v101
    v_dot2c_f32_bf16 v99, v189, v189
    v_dot2c_f32_bf16 v100, v189, v109
    v_dot2c_f32_bf16 v98, v190, v101
    v_dot2c_f32_bf16 v99, v190, v190
    v_dot2c_f32_bf16 v100, v190, v110
    v_dot2c_f32_bf16 v98, v191, v101
    v_dot2c_f32_bf16 v99, v191, v191
    v_dot2c_f32_bf16 v100, v191, v111
    v_dot2c_f32_bf16 v98, v192, v101
    v_dot2c_f32_bf16 v99, v192, v192
    v_dot2c_f32_bf16 v100, v192, v112
    v_dot2c_f32_bf16 v98, v193, v101
    v_dot2c_f32_bf16 v99, v193, v193
    v_dot2c_f32_bf16 v100, v193, v113
    v_dot2c_f32_bf16 v98, v194, v101
    v_dot2c_f32_bf16 v99, v194, v194
    v_dot2c_f32_bf16 v100, v194, v114
    v_dot2c_f32_bf16 v98, v195, v101
    v_dot2c_f32_bf16 v99, v195, v195
    v_dot2c_f32_bf16 v100, v195, v115
    v_dot2c_f32_bf16 v98, v196, v101
    v_dot2c_f32_bf16 v99, v196, v196
    v_dot2c_f32_bf16 v100, v196, v116
    v_dot2c_f32_bf16 v98, v197, v101
    v_dot2c_f32_bf16 v99, v197, v197
    v_dot2c_f32_bf16 v100, v197, v117
    v_dot2c_f32_bf16 v98, v198, v101
    v_dot2c_f32_bf16 v99, v198, v198
    v_dot2c_f32_bf16 v100, v198, v118
    v_dot2c_f32_bf16 v98, v199, v101
    v_dot2c_f32_bf16 v99, v199, v199
    v_dot2c_f32_bf16 v100, v199, v119
    v_dot2c_f32_bf16 v98, v200, v101
    v_dot2c_f32_bf16 v99, v200, v200
    v_dot2c_f32_bf16 v100, v200, v120
    v_dot2c_f32_bf16 v98, v201, v101
    v_dot2c_f32_bf16 v99, v201, v201
    v_dot2c_f32_bf16 v100, v201, v121
    v_dot2c_f32_bf16 v98, v202, v101
    v_dot2c_f32_bf16 v99, v202, v202
    v_dot2c_f32_bf16 v100, v202, v122
    v_dot2c_f32_bf16 v98, v203, v101
    v_dot2c_f32_bf16 v99, v203, v203
    v_dot2c_f32_bf16 v100, v203, v123
    v_dot2c_f32_bf16 v98, v204, v101
    v_dot2c_f32_bf16 v99, v204, v204
    v_dot2c_f32_bf16 v100, v204, v124
    v_dot2c_f32_bf16 v98, v205, v101
    v_dot2c_f32_bf16 v99, v205, v205
    v_dot2c_f32_bf16 v100, v205, v125
    v_dot2c_f32_bf16 v98, v206, v101
    v_dot2c_f32_bf16 v99, v206, v206
    v_dot2c_f32_bf16 v100, v206, v126
    v_dot2c_f32_bf16 v98, v207, v101
    v_dot2c_f32_bf16 v99, v207, v207
    v_dot2c_f32_bf16 v100, v207, v127
    s_nop 0
    v_add_f32_dpp v98, v98, v98 row_ror:8 row_mask:0xf bank_mask:0xf
    v_add_f32_dpp v99, v99, v99 row_ror:8 row_mask:0xf bank_mask:0xf
    v_add_f32_dpp v100, v100, v100 row_ror:8 row_mask:0xf bank_mask:0xf
    v_add_f32_dpp v98, v98, v98 row_ror:4 row_mask:0xf bank_mask:0xf
    v_add_f32_dpp v99, v99, v99 row_ror:4 row_mask:0xf bank_mask:0xf
    v_add_f32_dpp v100, v100, v100 row_ror:4 row_mask:0xf bank_mask:0xf
    v_add_f32_dpp v98, v98, v98 row_ror:2 row_mask:0xf bank_mask:0xf
    v_add_f32_dpp v99, v99, v99 row_ror:2 row_mask:0xf bank_mask:0xf
    v_add_f32_dpp v100, v100, v100 row_ror:2 row_mask:0xf bank_mask:0xf
    v_add_f32_dpp v98, v98, v98 row_ror:1 row_mask:0xf bank_mask:0xf
    v_add_f32_dpp v99, v99, v99 row_ror:1 row_mask:0xf bank_mask:0xf
    v_add_f32_dpp v100, v100, v100 row_ror:1 row_mask:0xf bank_mask:0xf
    v_mul_f32 v98, 0x3acccccd, v98
    v_mul_f32 v99, 0x3acccccd, v99
    v_mul_f32 v100, 0xbfb8aa3b, v100
    v_fma_f32 v99, -v98, v98, v99
    v_exp_f32 v100, v100
    v_max_f32 v99, 0, v99
    v_add_f32 v99, 0x3727c5ac, v99
    v_add_f32 v100, 1.0, v100
    v_rsq_f32 v103, v99
    v_rcp_f32 v100, v100
    v_mul_f32 v102, v98, v103
    v_sub_f32 v102, 0, v102
    v_cmp_eq_u32 s[52:53], 3, v104
    s_nop 1
    v_cndmask_b32 v106, v106, v102, s[52:53]
    v_cndmask_b32 v107, v107, v103, s[52:53]
    v_cndmask_b32 v105, v105, v100, s[52:53]
    v_lshrrev_b32 v102, 4, v1
    v_lshl_add_u32 v102, v104, 2, v102
    v_add_u32 v102, s85, v102
    v_mov_b32 v98, 0x7ffffff0
    v_cmp_gt_u32 s[52:53], 4, v104
    v_lshlrev_b32 v103, 3, v102
    s_nop 0
    v_cndmask_b32 v103, v98, v103, s[52:53]
    v_lshlrev_b32 v102, 2, v102
    v_cndmask_b32 v102, v98, v102, s[52:53]
    s_mov_b32 s48, 0
    buffer_store_dwordx2 v[106:107], v103, s[36:39], s48 offen sc1
    s_mov_b32 s48, 2621440
    buffer_store_dword v105, v102, s[36:39], s48 offen sc1
    s_mov_b32 s32, s14
    s_and_b32 s33, s15, 0xffff
    s_mov_b32 s34, 3456
    s_mov_b32 s35, 0x20000
    s_lshl_b32 s49, s56, 8
    v_lshlrev_b32 v4, 1, v0
    v_add_u32 v4, s49, v4
    buffer_load_ushort v4, v4, s[32:35], 0 offen
    v_mov_b32 v6, 0x00003f80
    v_mov_b32 v7, 0x3f800000
    v_mov_b32 v8, 0
    v_mov_b32 v9, 0
    v_mov_b32 v10, 0
    v_mov_b32 v11, 0
    v_mov_b32 v12, 0
    v_mov_b32 v13, 0
    v_mov_b32 v14, 0
    v_mov_b32 v15, 0
    s_waitcnt vmcnt(23)
    v_dot2c_f32_bf16 v8, v16, v6
    v_dot2c_f32_bf16 v9, v16, v7
    v_dot2c_f32_bf16 v10, v17, v6
    v_dot2c_f32_bf16 v11, v17, v7
    v_dot2c_f32_bf16 v12, v18, v6
    v_dot2c_f32_bf16 v13, v18, v7
    v_dot2c_f32_bf16 v14, v19, v6
    v_dot2c_f32_bf16 v15, v19, v7
    s_waitcnt vmcnt(22)
    v_dot2c_f32_bf16 v8, v20, v6
    v_dot2c_f32_bf16 v9, v20, v7
    v_dot2c_f32_bf16 v10, v21, v6
    v_dot2c_f32_bf16 v11, v21, v7
    v_dot2c_f32_bf16 v12, v22, v6
    v_dot2c_f32_bf16 v13, v22, v7
    v_dot2c_f32_bf16 v14, v23, v6
    v_dot2c_f32_bf16 v15, v23, v7
    s_waitcnt vmcnt(21)
    v_dot2c_f32_bf16 v8, v24, v6
    v_dot2c_f32_bf16 v9, v24, v7
    v_dot2c_f32_bf16 v10, v25, v6
    v_dot2c_f32_bf16 v11, v25, v7
    v_dot2c_f32_bf16 v12, v26, v6
    v_dot2c_f32_bf16 v13, v26, v7
    v_dot2c_f32_bf16 v14, v27, v6
    v_dot2c_f32_bf16 v15, v27, v7
    s_waitcnt vmcnt(20)
    v_dot2c_f32_bf16 v8, v28, v6
    v_dot2c_f32_bf16 v9, v28, v7
    v_dot2c_f32_bf16 v10, v29, v6
    v_dot2c_f32_bf16 v11, v29, v7
    v_dot2c_f32_bf16 v12, v30, v6
    v_dot2c_f32_bf16 v13, v30, v7
    v_dot2c_f32_bf16 v14, v31, v6
    v_dot2c_f32_bf16 v15, v31, v7
    s_waitcnt vmcnt(19)
    v_dot2c_f32_bf16 v8, v32, v6
    v_dot2c_f32_bf16 v9, v32, v7
    v_dot2c_f32_bf16 v10, v33, v6
    v_dot2c_f32_bf16 v11, v33, v7
    v_dot2c_f32_bf16 v12, v34, v6
    v_dot2c_f32_bf16 v13, v34, v7
    v_dot2c_f32_bf16 v14, v35, v6
    v_dot2c_f32_bf16 v15, v35, v7
    s_waitcnt vmcnt(18)
    v_dot2c_f32_bf16 v8, v36, v6
    v_dot2c_f32_bf16 v9, v36, v7
    v_dot2c_f32_bf16 v10, v37, v6
    v_dot2c_f32_bf16 v11, v37, v7
    v_dot2c_f32_bf16 v12, v38, v6
    v_dot2c_f32_bf16 v13, v38, v7
    v_dot2c_f32_bf16 v14, v39, v6
    v_dot2c_f32_bf16 v15, v39, v7
    s_waitcnt vmcnt(17)
    v_dot2c_f32_bf16 v8, v40, v6
    v_dot2c_f32_bf16 v9, v40, v7
    v_dot2c_f32_bf16 v10, v41, v6
    v_dot2c_f32_bf16 v11, v41, v7
    v_dot2c_f32_bf16 v12, v42, v6
    v_dot2c_f32_bf16 v13, v42, v7
    v_dot2c_f32_bf16 v14, v43, v6
    v_dot2c_f32_bf16 v15, v43, v7
    s_waitcnt vmcnt(16)
    v_dot2c_f32_bf16 v8, v44, v6
    v_dot2c_f32_bf16 v9, v44, v7
    v_dot2c_f32_bf16 v10, v45, v6
    v_dot2c_f32_bf16 v11, v45, v7
    v_dot2c_f32_bf16 v12, v46, v6
    v_dot2c_f32_bf16 v13, v46, v7
    v_dot2c_f32_bf16 v14, v47, v6
    v_dot2c_f32_bf16 v15, v47, v7
    s_waitcnt vmcnt(15)
    v_dot2c_f32_bf16 v8, v48, v6
    v_dot2c_f32_bf16 v9, v48, v7
    v_dot2c_f32_bf16 v10, v49, v6
    v_dot2c_f32_bf16 v11, v49, v7
    v_dot2c_f32_bf16 v12, v50, v6
    v_dot2c_f32_bf16 v13, v50, v7
    v_dot2c_f32_bf16 v14, v51, v6
    v_dot2c_f32_bf16 v15, v51, v7
    s_waitcnt vmcnt(14)
    v_dot2c_f32_bf16 v8, v52, v6
    v_dot2c_f32_bf16 v9, v52, v7
    v_dot2c_f32_bf16 v10, v53, v6
    v_dot2c_f32_bf16 v11, v53, v7
    v_dot2c_f32_bf16 v12, v54, v6
    v_dot2c_f32_bf16 v13, v54, v7
    v_dot2c_f32_bf16 v14, v55, v6
    v_dot2c_f32_bf16 v15, v55, v7
    s_waitcnt vmcnt(13)
    v_dot2c_f32_bf16 v8, v56, v6
    v_dot2c_f32_bf16 v9, v56, v7
    v_dot2c_f32_bf16 v10, v57, v6
    v_dot2c_f32_bf16 v11, v57, v7
    v_dot2c_f32_bf16 v12, v58, v6
    v_dot2c_f32_bf16 v13, v58, v7
    v_dot2c_f32_bf16 v14, v59, v6
    v_dot2c_f32_bf16 v15, v59, v7
    s_waitcnt vmcnt(12)
    v_dot2c_f32_bf16 v8, v60, v6
    v_dot2c_f32_bf16 v9, v60, v7
    v_dot2c_f32_bf16 v10, v61, v6
    v_dot2c_f32_bf16 v11, v61, v7
    v_dot2c_f32_bf16 v12, v62, v6
    v_dot2c_f32_bf16 v13, v62, v7
    v_dot2c_f32_bf16 v14, v63, v6
    v_dot2c_f32_bf16 v15, v63, v7
    s_waitcnt vmcnt(11)
    v_dot2c_f32_bf16 v8, v64, v6
    v_dot2c_f32_bf16 v9, v64, v7
    v_dot2c_f32_bf16 v10, v65, v6
    v_dot2c_f32_bf16 v11, v65, v7
    v_dot2c_f32_bf16 v12, v66, v6
    v_dot2c_f32_bf16 v13, v66, v7
    v_dot2c_f32_bf16 v14, v67, v6
    v_dot2c_f32_bf16 v15, v67, v7
    s_waitcnt vmcnt(10)
    v_dot2c_f32_bf16 v8, v68, v6
    v_dot2c_f32_bf16 v9, v68, v7
    v_dot2c_f32_bf16 v10, v69, v6
    v_dot2c_f32_bf16 v11, v69, v7
    v_dot2c_f32_bf16 v12, v70, v6
    v_dot2c_f32_bf16 v13, v70, v7
    v_dot2c_f32_bf16 v14, v71, v6
    v_dot2c_f32_bf16 v15, v71, v7
    s_waitcnt vmcnt(9)
    v_dot2c_f32_bf16 v8, v72, v6
    v_dot2c_f32_bf16 v9, v72, v7
    v_dot2c_f32_bf16 v10, v73, v6
    v_dot2c_f32_bf16 v11, v73, v7
    v_dot2c_f32_bf16 v12, v74, v6
    v_dot2c_f32_bf16 v13, v74, v7
    v_dot2c_f32_bf16 v14, v75, v6
    v_dot2c_f32_bf16 v15, v75, v7
    s_waitcnt vmcnt(8)
    v_dot2c_f32_bf16 v8, v76, v6
    v_dot2c_f32_bf16 v9, v76, v7
    v_dot2c_f32_bf16 v10, v77, v6
    v_dot2c_f32_bf16 v11, v77, v7
    v_dot2c_f32_bf16 v12, v78, v6
    v_dot2c_f32_bf16 v13, v78, v7
    v_dot2c_f32_bf16 v14, v79, v6
    v_dot2c_f32_bf16 v15, v79, v7
    s_waitcnt vmcnt(7)
    v_dot2c_f32_bf16 v8, v80, v6
    v_dot2c_f32_bf16 v9, v80, v7
    v_dot2c_f32_bf16 v10, v81, v6
    v_dot2c_f32_bf16 v11, v81, v7
    v_dot2c_f32_bf16 v12, v82, v6
    v_dot2c_f32_bf16 v13, v82, v7
    v_dot2c_f32_bf16 v14, v83, v6
    v_dot2c_f32_bf16 v15, v83, v7
    s_waitcnt vmcnt(6)
    v_dot2c_f32_bf16 v8, v84, v6
    v_dot2c_f32_bf16 v9, v84, v7
    v_dot2c_f32_bf16 v10, v85, v6
    v_dot2c_f32_bf16 v11, v85, v7
    v_dot2c_f32_bf16 v12, v86, v6
    v_dot2c_f32_bf16 v13, v86, v7
    v_dot2c_f32_bf16 v14, v87, v6
    v_dot2c_f32_bf16 v15, v87, v7
    s_waitcnt vmcnt(5)
    v_dot2c_f32_bf16 v8, v88, v6
    v_dot2c_f32_bf16 v9, v88, v7
    v_dot2c_f32_bf16 v10, v89, v6
    v_dot2c_f32_bf16 v11, v89, v7
    v_dot2c_f32_bf16 v12, v90, v6
    v_dot2c_f32_bf16 v13, v90, v7
    v_dot2c_f32_bf16 v14, v91, v6
    v_dot2c_f32_bf16 v15, v91, v7
    s_waitcnt vmcnt(4)
    v_dot2c_f32_bf16 v8, v92, v6
    v_dot2c_f32_bf16 v9, v92, v7
    v_dot2c_f32_bf16 v10, v93, v6
    v_dot2c_f32_bf16 v11, v93, v7
    v_dot2c_f32_bf16 v12, v94, v6
    v_dot2c_f32_bf16 v13, v94, v7
    v_dot2c_f32_bf16 v14, v95, v6
    v_dot2c_f32_bf16 v15, v95, v7
    v_lshrrev_b32 v2, 4, v0
    v_lshlrev_b32 v2, 9, v2
    v_and_b32 v3, 15, v0
    v_lshl_add_u32 v2, v3, 5, v2
    ds_write_b128 v2, v[8:11]
    ds_write_b128 v2, v[12:15] offset:16
    s_waitcnt lgkmcnt(0)
    s_barrier
    v_and_b32 v2, 127, v0
    v_lshlrev_b32 v2, 2, v2
    ds_read_b32 v16, v2 offset:0
    ds_read_b32 v17, v2 offset:512
    ds_read_b32 v18, v2 offset:1024
    ds_read_b32 v19, v2 offset:1536
    ds_read_b32 v20, v2 offset:2048
    ds_read_b32 v21, v2 offset:2560
    ds_read_b32 v22, v2 offset:3072
    ds_read_b32 v23, v2 offset:3584
    ds_read_b32 v24, v2 offset:4096
    ds_read_b32 v25, v2 offset:4608
    ds_read_b32 v26, v2 offset:5120
    ds_read_b32 v27, v2 offset:5632
    ds_read_b32 v28, v2 offset:6144
    ds_read_b32 v29, v2 offset:6656
    ds_read_b32 v30, v2 offset:7168
    ds_read_b32 v31, v2 offset:7680
    ds_read_b32 v32, v2 offset:8192
    ds_read_b32 v33, v2 offset:8704
    ds_read_b32 v34, v2 offset:9216
    ds_read_b32 v35, v2 offset:9728
    ds_read_b32 v36, v2 offset:10240
    ds_read_b32 v37, v2 offset:10752
    ds_read_b32 v38, v2 offset:11264
    ds_read_b32 v39, v2 offset:11776
    ds_read_b32 v40, v2 offset:12288
    ds_read_b32 v41, v2 offset:12800
    ds_read_b32 v42, v2 offset:13312
    ds_read_b32 v43, v2 offset:13824
    ds_read_b32 v44, v2 offset:14336
    ds_read_b32 v45, v2 offset:14848
    ds_read_b32 v46, v2 offset:15360
    ds_read_b32 v47, v2 offset:15872
    s_waitcnt lgkmcnt(0)
    v_add_f32 v16, v16, v17
    v_add_f32 v18, v18, v19
    v_add_f32 v20, v20, v21
    v_add_f32 v22, v22, v23
    v_add_f32 v24, v24, v25
    v_add_f32 v26, v26, v27
    v_add_f32 v28, v28, v29
    v_add_f32 v30, v30, v31
    v_add_f32 v32, v32, v33
    v_add_f32 v34, v34, v35
    v_add_f32 v36, v36, v37
    v_add_f32 v38, v38, v39
    v_add_f32 v40, v40, v41
    v_add_f32 v42, v42, v43
    v_add_f32 v44, v44, v45
    v_add_f32 v46, v46, v47
    v_add_f32 v16, v16, v18
    v_add_f32 v16, v16, v20
    v_add_f32 v16, v16, v22
    v_add_f32 v16, v16, v24
    v_add_f32 v16, v16, v26
    v_add_f32 v16, v16, v28
    v_add_f32 v16, v16, v30
    v_add_f32 v16, v16, v32
    v_add_f32 v16, v16, v34
    v_add_f32 v16, v16, v36
    v_add_f32 v16, v16, v38
    v_add_f32 v16, v16, v40
    v_add_f32 v16, v16, v42
    v_add_f32 v16, v16, v44
    v_add_f32 v16, v16, v46
    s_waitcnt vmcnt(0)
    v_lshlrev_b32 v4, 16, v4
    s_lshl_b32 s49, s56, 9
    v_add_u32 v2, s49, v2
    v_mov_b32 v3, 0x7ffffff0
    v_mov_b32 v6, 128
    v_cmp_gt_u32 s[52:53], v6, v0
    s_nop 1
    v_cndmask_b32 v2, v3, v2, s[52:53]
    s_mov_b32 s48, 0x7fff0000
    s_cmp_lt_u32 s56, 14
    s_cselect_b32 s50, 65536, s48
    s_cselect_b32 s51, 73728, s48
    buffer_store_dword v16, v2, s[36:39], s50 offen sc1
    buffer_store_dword v4, v2, s[36:39], s51 offen sc1
ng_11:
    v_readfirstlane_b32 s96, v252
    s_nop 0
    s_cmp_lg_u32 s96, 0
    s_cbranch_scc1 ng_11_ok
    s_sleep 2
    global_load_dword v252, v253, s[24:25] sc1
    s_waitcnt vmcnt(0)
    s_branch ng_11
ng_11_ok:
    s_waitcnt vmcnt(0)
    s_barrier
    s_lshl_b32 s48, s56, 7
    s_add_u32 s48, s48, 25165824
    v_mov_b32 v29, s96
    buffer_store_dword v29, v250, s[36:39], s48 offen sc1
    s_lshl_b32 s48, s56, 2
    s_add_u32 s48, s48, 25175040
    v_mov_b32 v29, s96
    buffer_store_dword v29, v250, s[36:39], s48 offen sc1
    s_mul_i32 s48, s47, 3
    s_lshl_b32 s49, s47, 1
    s_add_u32 s49, s49, 10
    s_cmp_lt_u32 s47, 10
    s_cselect_b32 s48, s48, s49
    s_cselect_b32 s49, 3, 2
    s_sub_u32 s50, s44, 4
    s_add_u32 s82, s48, s50
    s_cmp_lt_u32 s50, s49
    s_cselect_b32 s82, s82, 0x100
    s_cselect_b32 s83, 0, 0x7fff0000
    s_mul_i32 s50, s50, 5120
    s_add_u32 s50, s50, 147456
    s_cmp_lt_u32 s82, 74
    s_cselect_b32 s84, s50, 163840
    v_mov_b32 v128, 0
    v_mov_b32 v129, 0
    v_mov_b32 v130, 0
    v_mov_b32 v131, 0
    v_mov_b32 v132, 0
    s_mov_b32 s40, s16
    s_and_b32 s41, s17, 0xffff
    s_mov_b32 s42, 2211840
    s_mov_b32 s43, 0x20000
    s_cmp_ge_u32 s82, 74
    s_cbranch_scc1 s1_pai_go
    s_movk_i32 s54, 6554
    s_movk_i32 s55, 1280
    s_mul_i32 s50, s46, 160
    s_cmp_ge_u32 s82, 54
    s_cbranch_scc1 s1_pai_wo
    s_lshl_b32 s51, s82, 5
    v_add_u32 v176, 0, v1
    v_mul_u32_u24 v177, s54, v176
    v_lshrrev_b32 v177, 16, v177
    v_mul_u32_u24 v178, 10, v177
    v_sub_u32 v178, v176, v178
    v_add_u32 v177, s51, v177
    v_mul_lo_u32 v177, v177, s55
    v_lshl_add_u32 v177, v178, 4, v177
    v_add_u32 v128, s50, v177
    v_add_u32 v176, 64, v1
    v_mul_u32_u24 v177, s54, v176
    v_lshrrev_b32 v177, 16, v177
    v_mul_u32_u24 v178, 10, v177
    v_sub_u32 v178, v176, v178
    v_add_u32 v177, s51, v177
    v_mul_lo_u32 v177, v177, s55
    v_lshl_add_u32 v177, v178, 4, v177
    v_add_u32 v129, s50, v177
    v_add_u32 v176, 128, v1
    v_mul_u32_u24 v177, s54, v176
    v_lshrrev_b32 v177, 16, v177
    v_mul_u32_u24 v178, 10, v177
    v_sub_u32 v178, v176, v178
    v_add_u32 v177, s51, v177
    v_mul_lo_u32 v177, v177, s55
    v_lshl_add_u32 v177, v178, 4, v177
    v_add_u32 v130, s50, v177
    v_add_u32 v176, 192, v1
    v_mul_u32_u24 v177, s54, v176
    v_lshrrev_b32 v177, 16, v177
    v_mul_u32_u24 v178, 10, v177
    v_sub_u32 v178, v176, v178
    v_add_u32 v177, s51, v177
    v_mul_lo_u32 v177, v177, s55
    v_lshl_add_u32 v177, v178, 4, v177
    v_add_u32 v131, s50, v177
    v_add_u32 v176, 256, v1
    v_mul_u32_u24 v177, s54, v176
    v_lshrrev_b32 v177, 16, v177
    v_mul_u32_u24 v178, 10, v177
    v_sub_u32 v178, v176, v178
    v_add_u32 v177, s51, v177
    v_mul_lo_u32 v177, v177, s55
    v_lshl_add_u32 v177, v178, 4, v177
    v_add_u32 v132, s50, v177
    s_branch s1_pai_go
s1_pai_wo:
    s_mov_b32 s40, s8
    s_and_b32 s41, s9, 0xffff
    s_mov_b32 s42, 819200
    s_mov_b32 s43, 0x20000
    s_sub_u32 s51, s82, 54
    s_lshl_b32 s51, s51, 1
    v_add_u32 v176, 0, v1
    v_mul_u32_u24 v177, s54, v176
    v_lshrrev_b32 v177, 16, v177
    v_mul_u32_u24 v178, 10, v177
    v_sub_u32 v178, v176, v178
    v_lshrrev_b32 v179, 4, v177
    v_add_u32 v179, s51, v179
    v_and_b32 v177, 15, v177
    v_mul_u32_u24 v180, 20, v179
    v_add_u32 v180, v180, v177
    v_cmp_gt_u32 s[98:99], 32, v179
    v_subrev_u32 v179, 32, v179
    v_lshlrev_b32 v179, 2, v179
    v_bfe_u32 v181, v177, 2, 1
    v_lshl_add_u32 v179, v181, 1, v179
    v_lshrrev_b32 v181, 3, v177
    v_add_u32 v179, v179, v181
    v_mul_u32_u24 v179, 20, v179
    v_and_b32 v177, 3, v177
    v_add3_u32 v179, v179, v177, 16
    v_cndmask_b32 v177, v179, v180, s[98:99]
    v_mul_lo_u32 v177, v177, s55
    v_lshl_add_u32 v177, v178, 4, v177
    v_add_u32 v128, s50, v177
    v_add_u32 v176, 64, v1
    v_mul_u32_u24 v177, s54, v176
    v_lshrrev_b32 v177, 16, v177
    v_mul_u32_u24 v178, 10, v177
    v_sub_u32 v178, v176, v178
    v_lshrrev_b32 v179, 4, v177
    v_add_u32 v179, s51, v179
    v_and_b32 v177, 15, v177
    v_mul_u32_u24 v180, 20, v179
    v_add_u32 v180, v180, v177
    v_cmp_gt_u32 s[98:99], 32, v179
    v_subrev_u32 v179, 32, v179
    v_lshlrev_b32 v179, 2, v179
    v_bfe_u32 v181, v177, 2, 1
    v_lshl_add_u32 v179, v181, 1, v179
    v_lshrrev_b32 v181, 3, v177
    v_add_u32 v179, v179, v181
    v_mul_u32_u24 v179, 20, v179
    v_and_b32 v177, 3, v177
    v_add3_u32 v179, v179, v177, 16
    v_cndmask_b32 v177, v179, v180, s[98:99]
    v_mul_lo_u32 v177, v177, s55
    v_lshl_add_u32 v177, v178, 4, v177
    v_add_u32 v129, s50, v177
    v_add_u32 v176, 128, v1
    v_mul_u32_u24 v177, s54, v176
    v_lshrrev_b32 v177, 16, v177
    v_mul_u32_u24 v178, 10, v177
    v_sub_u32 v178, v176, v178
    v_lshrrev_b32 v179, 4, v177
    v_add_u32 v179, s51, v179
    v_and_b32 v177, 15, v177
    v_mul_u32_u24 v180, 20, v179
    v_add_u32 v180, v180, v177
    v_cmp_gt_u32 s[98:99], 32, v179
    v_subrev_u32 v179, 32, v179
    v_lshlrev_b32 v179, 2, v179
    v_bfe_u32 v181, v177, 2, 1
    v_lshl_add_u32 v179, v181, 1, v179
    v_lshrrev_b32 v181, 3, v177
    v_add_u32 v179, v179, v181
    v_mul_u32_u24 v179, 20, v179
    v_and_b32 v177, 3, v177
    v_add3_u32 v179, v179, v177, 16
    v_cndmask_b32 v177, v179, v180, s[98:99]
    v_mul_lo_u32 v177, v177, s55
    v_lshl_add_u32 v177, v178, 4, v177
    v_add_u32 v130, s50, v177
    v_add_u32 v176, 192, v1
    v_mul_u32_u24 v177, s54, v176
    v_lshrrev_b32 v177, 16, v177
    v_mul_u32_u24 v178, 10, v177
    v_sub_u32 v178, v176, v178
    v_lshrrev_b32 v179, 4, v177
    v_add_u32 v179, s51, v179
    v_and_b32 v177, 15, v177
    v_mul_u32_u24 v180, 20, v179
    v_add_u32 v180, v180, v177
    v_cmp_gt_u32 s[98:99], 32, v179
    v_subrev_u32 v179, 32, v179
    v_lshlrev_b32 v179, 2, v179
    v_bfe_u32 v181, v177, 2, 1
    v_lshl_add_u32 v179, v181, 1, v179
    v_lshrrev_b32 v181, 3, v177
    v_add_u32 v179, v179, v181
    v_mul_u32_u24 v179, 20, v179
    v_and_b32 v177, 3, v177
    v_add3_u32 v179, v179, v177, 16
    v_cndmask_b32 v177, v179, v180, s[98:99]
    v_mul_lo_u32 v177, v177, s55
    v_lshl_add_u32 v177, v178, 4, v177
    v_add_u32 v131, s50, v177
    v_add_u32 v176, 256, v1
    v_mul_u32_u24 v177, s54, v176
    v_lshrrev_b32 v177, 16, v177
    v_mul_u32_u24 v178, 10, v177
    v_sub_u32 v178, v176, v178
    v_lshrrev_b32 v179, 4, v177
    v_add_u32 v179, s51, v179
    v_and_b32 v177, 15, v177
    v_mul_u32_u24 v180, 20, v179
    v_add_u32 v180, v180, v177
    v_cmp_gt_u32 s[98:99], 32, v179
    v_subrev_u32 v179, 32, v179
    v_lshlrev_b32 v179, 2, v179
    v_bfe_u32 v181, v177, 2, 1
    v_lshl_add_u32 v179, v181, 1, v179
    v_lshrrev_b32 v181, 3, v177
    v_add_u32 v179, v179, v181
    v_mul_u32_u24 v179, 20, v179
    v_and_b32 v177, 3, v177
    v_add3_u32 v179, v179, v177, 16
    v_cndmask_b32 v177, v179, v180, s[98:99]
    v_mul_lo_u32 v177, v177, s55
    v_lshl_add_u32 v177, v178, 4, v177
    v_add_u32 v132, s50, v177
s1_pai_go:
    s_add_u32 m0, s84, 0
    s_nop 0
    buffer_load_dwordx4 v128, s[40:43], s83 offen lds
    s_add_u32 m0, s84, 1024
    s_nop 0
    buffer_load_dwordx4 v129, s[40:43], s83 offen lds
    s_add_u32 m0, s84, 2048
    s_nop 0
    buffer_load_dwordx4 v130, s[40:43], s83 offen lds
    s_add_u32 m0, s84, 3072
    s_nop 0
    buffer_load_dwordx4 v131, s[40:43], s83 offen lds
    s_add_u32 m0, s84, 4096
    s_nop 0
    buffer_load_dwordx4 v132, s[40:43], s83 offen lds
    s_waitcnt vmcnt(0)
    v_mov_b32 v135, 0x7ffffff0
    s_cmp_ge_u32 s82, 74
    s_cbranch_scc1 rf_12
    s_mul_i32 s48, s46, 378880
    s_mul_i32 s49, s82, 5120
    s_add_u32 s48, s48, s49
    s_add_u32 s48, s48, 22020096
    v_lshlrev_b32 v135, 4, v1
    v_add_u32 v135, s48, v135
    v_lshrrev_b32 v134, 5, v1
    v_bfe_u32 v136, v1, 4, 1
    v_lshlrev_b32 v134, 4, v134
    v_lshl_add_u32 v134, v136, 2, v134
    v_bfe_u32 v136, v1, 2, 2
    v_add_u32 v134, v134, v136
    v_mul_u32_u24 v134, 160, v134
    v_and_b32 v136, 3, v1
    v_lshl_add_u32 v134, v136, 3, v134
    v_add_u32 v134, s84, v134
    ds_read_b64_tr_b16 v[136:137], v134 offset:0
    ds_read_b64_tr_b16 v[138:139], v134 offset:1280
    ds_read_b64_tr_b16 v[140:141], v134 offset:32
    ds_read_b64_tr_b16 v[142:143], v134 offset:1312
    ds_read_b64_tr_b16 v[144:145], v134 offset:64
    ds_read_b64_tr_b16 v[146:147], v134 offset:1344
    ds_read_b64_tr_b16 v[148:149], v134 offset:96
    ds_read_b64_tr_b16 v[150:151], v134 offset:1376
    ds_read_b64_tr_b16 v[152:153], v134 offset:128
    ds_read_b64_tr_b16 v[154:155], v134 offset:1408
    s_waitcnt lgkmcnt(0)
rf_12:
    s_movk_i32 s49, 0
    buffer_store_dwordx4 v[136:139], v135, s[36:39], s49 offen sc1
    s_movk_i32 s49, 1024
    buffer_store_dwordx4 v[140:143], v135, s[36:39], s49 offen sc1
    s_movk_i32 s49, 2048
    buffer_store_dwordx4 v[144:147], v135, s[36:39], s49 offen sc1
    s_movk_i32 s49, 3072
    buffer_store_dwordx4 v[148:151], v135, s[36:39], s49 offen sc1
    s_movk_i32 s49, 4096
    buffer_store_dwordx4 v[152:155], v135, s[36:39], s49 offen sc1
    s_waitcnt vmcnt(0)
    s_barrier
    s_lshl_b32 s48, s46, 7
    s_lshl_b32 s49, s47, 2
    s_add_u32 s48, s48, s49
    s_add_u32 s48, s48, 25167872
    v_mov_b32 v29, s96
    buffer_store_dword v29, v250, s[36:39], s48 offen sc1
    s_mov_b32 s86, 0x7fff0000
    v_lshrrev_b32 v30, 4, v1
    s_sub_u32 s48, s88, 2
    v_add_u32 v30, s48, v30
    v_and_b32 v29, 15, v1
    v_cmp_le_i32 s[52:53], 0, v30
    v_cmp_gt_u32 s[50:51], 15, v29
    s_nop 0
    s_and_b64 s[52:53], s[52:53], s[50:51]
    s_mov_b32 s50, -1
    s_mov_b32 s51, 0xffff
    s_and_b64 s[52:53], s[52:53], s[50:51]
    v_lshlrev_b32 v30, 7, v30
    v_lshl_add_u32 v30, v29, 2, v30
    s_lshl_b32 s48, s88, 7
    v_mov_b32 v29, s48
    v_cndmask_b32 v30, v29, v30, s[52:53]
    v_add_u32 v30, 25168896, v30
    s_mov_b64 s[52:53], -1
    s_cmp_lg_u32 s44, 0
    s_cbranch_scc1 wf_13_done
    s_mov_b64 exec, s[52:53]
wf_13:
    buffer_load_dword v31, v30, s[36:39], 0 offen sc1
    s_waitcnt vmcnt(0)
    v_cmp_ne_u32 vcc, s96, v31
    s_nop 4
    s_cbranch_vccz wf_13_ok
    s_sleep 1
    s_branch wf_13
wf_13_ok:
    s_mov_b64 exec, -1
wf_13_done:
    s_barrier
    s_cmp_ge_u32 s44, 4
    s_cbranch_scc1 ik_14
    v_lshlrev_b32 v3, 4, v1
    s_mul_i32 s50, s89, 163840
    s_lshl_b32 s48, s88, 10
    s_add_u32 s50, s50, s48
    s_add_u32 s50, s50, 3145728
    s_add_u32 s48, s44, 0
    s_lshl_b32 s49, s48, 14
    s_add_u32 s49, s49, s50
    s_lshl_b32 s51, s48, 10
    s_add_u32 s51, s51, 81920
    s_mov_b32 m0, s51
    s_nop 0
    buffer_load_dwordx4 v3, s[36:39], s49 offen sc1 lds
    s_add_u32 s48, s44, 4
    s_lshl_b32 s49, s48, 14
    s_add_u32 s49, s49, s50
    s_lshl_b32 s51, s48, 10
    s_add_u32 s51, s51, 81920
    s_mov_b32 m0, s51
    s_nop 0
    buffer_load_dwordx4 v3, s[36:39], s49 offen sc1 lds
    s_add_u32 s48, s44, 8
    s_lshl_b32 s49, s48, 14
    s_add_u32 s49, s49, s50
    s_lshl_b32 s51, s48, 10
    s_add_u32 s51, s51, 81920
    s_cmp_lt_u32 s48, 10
    s_cselect_b32 s49, s49, 0x7fff0000
    s_mov_b32 m0, s51
    s_nop 0
    buffer_load_dwordx4 v3, s[36:39], s49 offen sc1 lds
    s_sub_u32 s48, s88, 2
    s_lshl_b32 s48, s48, 7
    s_mul_i32 s49, s44, 96
    s_add_u32 s48, s48, s49
    v_lshlrev_b32 v26, 1, v1
    v_add_u32 v26, s48, v26
    v_lshlrev_b32 v27, 3, v26
    v_mov_b32 v28, 0x7ffffff0
    v_cmp_le_i32 s[52:53], 0, v26
    s_nop 1
    v_cndmask_b32 v2, v28, v27, s[52:53]
    s_mul_i32 s50, s89, 163840
    s_add_u32 s50, s50, 5767168
    s_mul_i32 s51, s44, 768
    s_mov_b32 exec_hi, 0xffff
    s_add_u32 m0, s51, 98304
    s_add_u32 s54, s50, 0
    buffer_load_dwordx4 v2, s[36:39], s54 offen sc1 lds
    s_add_u32 m0, s51, 101408
    s_add_u32 s54, s50, 16384
    buffer_load_dwordx4 v2, s[36:39], s54 offen sc1 lds
    s_add_u32 m0, s51, 104512
    s_add_u32 s54, s50, 32768
    buffer_load_dwordx4 v2, s[36:39], s54 offen sc1 lds
    s_add_u32 m0, s51, 107616
    s_add_u32 s54, s50, 49152
    buffer_load_dwordx4 v2, s[36:39], s54 offen sc1 lds
    s_add_u32 m0, s51, 110720
    s_add_u32 s54, s50, 65536
    buffer_load_dwordx4 v2, s[36:39], s54 offen sc1 lds
    s_add_u32 m0, s51, 113824
    s_add_u32 s54, s50, 81920
    buffer_load_dwordx4 v2, s[36:39], s54 offen sc1 lds
    s_add_u32 m0, s51, 116928
    s_add_u32 s54, s50, 98304
    buffer_load_dwordx4 v2, s[36:39], s54 offen sc1 lds
    s_add_u32 m0, s51, 120032
    s_add_u32 s54, s50, 114688
    buffer_load_dwordx4 v2, s[36:39], s54 offen sc1 lds
    s_add_u32 m0, s51, 123136
    s_add_u32 s54, s50, 131072
    buffer_load_dwordx4 v2, s[36:39], s54 offen sc1 lds
    s_add_u32 m0, s51, 126240
    s_add_u32 s54, s50, 147456
    buffer_load_dwordx4 v2, s[36:39], s54 offen sc1 lds
    s_add_u32 m0, s51, 129344
    s_add_u32 s54, s50, 2621440
    buffer_load_dwordx4 v2, s[36:39], s54 offen sc1 lds
    s_add_u32 m0, s51, 132448
    s_add_u32 s54, s50, 2637824
    buffer_load_dwordx4 v2, s[36:39], s54 offen sc1 lds
    s_add_u32 m0, s51, 135552
    s_add_u32 s54, s50, 2654208
    buffer_load_dwordx4 v2, s[36:39], s54 offen sc1 lds
    s_add_u32 m0, s51, 138656
    s_add_u32 s54, s50, 2670592
    buffer_load_dwordx4 v2, s[36:39], s54 offen sc1 lds
    s_add_u32 m0, s51, 141760
    s_add_u32 s54, s50, 2686976
    buffer_load_dwordx4 v2, s[36:39], s54 offen sc1 lds
    s_add_u32 m0, s51, 144864
    s_add_u32 s54, s50, 2703360
    buffer_load_dwordx4 v2, s[36:39], s54 offen sc1 lds
    s_add_u32 m0, s51, 147968
    s_add_u32 s54, s50, 2719744
    buffer_load_dwordx4 v2, s[36:39], s54 offen sc1 lds
    s_add_u32 m0, s51, 151072
    s_add_u32 s54, s50, 2736128
    buffer_load_dwordx4 v2, s[36:39], s54 offen sc1 lds
    s_add_u32 m0, s51, 154176
    s_add_u32 s54, s50, 2752512
    buffer_load_dwordx4 v2, s[36:39], s54 offen sc1 lds
    s_add_u32 m0, s51, 157280
    s_add_u32 s54, s50, 2768896
    buffer_load_dwordx4 v2, s[36:39], s54 offen sc1 lds
    s_mov_b32 exec_hi, -1
    v_and_b32 v232, 31, v1
    v_lshlrev_b32 v232, 2, v232
    s_lshl_b32 s49, s74, 7
    s_add_u32 s49, s49, 25167872
    v_add_u32 v232, s49, v232
    buffer_load_dword v233, v232, s[36:39], 0 offen sc1
    s_waitcnt vmcnt(0)
    v_cmp_ne_u32 vcc, s96, v233
    s_nop 4
    s_cbranch_vccz pc_15_ok
pc_15:
    s_sleep 1
    buffer_load_dword v233, v232, s[36:39], 0 offen sc1
    s_waitcnt vmcnt(0)
    v_cmp_ne_u32 vcc, s96, v233
    s_nop 4
    s_cbranch_vccnz pc_15
pc_15_ok:
ik_14:
    s_waitcnt vmcnt(0)
s1_join:
    s_setprio 0
    v_and_b32 v6, 31, v1
    v_and_b32 v94, 15, v1
    v_min_u32 v94, 13, v94
    v_lshlrev_b32 v94, 2, v94
    s_lshr_b32 s49, s73, 1
    s_lshl_b32 s49, s49, 7
    s_add_u32 s49, s49, 25170944
    v_add_u32 v94, s49, v94
    v_lshrrev_b32 v7, 5, v1
    v_mov_b32 v28, 0x3f803f80
    v_mov_b32 v29, 0x3f803f80
    v_mov_b32 v30, 0x3f803f80
    v_mov_b32 v31, 0x3f803f80
    v_lshlrev_b32 v11, 4, v0
    v_add_u32 v11, 160384, v11
    v_mov_b32 v36, 208
    v_cmp_gt_u32 vcc, v36, v0
    s_nop 0
    s_and_saveexec_b64 s[52:53], vcc
    s_cbranch_execz on_16
    ds_write_b128 v11, v[28:31]
on_16:
    s_mov_b64 exec, s[52:53]
    v_lshlrev_b32 v8, 2, v7
    v_sub_u32 v8, v6, v8
    v_mov_b32 v248, v8
    v_mov_b32 v9, 0xffff
    v_mov_b32 v11, 0xffff0000
    v_cmp_le_i32 s[98:99], 0, v248
    v_cmp_le_i32 s[100:101], 1, v248
    s_nop 0
    v_cndmask_b32 v12, 0, v9, s[98:99]
    v_cndmask_b32 v36, 0, v11, s[100:101]
    v_or_b32 v12, v12, v36
    v_cmp_le_i32 s[98:99], 2, v248
    v_cmp_le_i32 s[100:101], 3, v248
    s_nop 0
    v_cndmask_b32 v13, 0, v9, s[98:99]
    v_cndmask_b32 v36, 0, v11, s[100:101]
    v_or_b32 v13, v13, v36
    v_cmp_le_i32 s[98:99], 8, v248
    v_cmp_le_i32 s[100:101], 9, v248
    s_nop 0
    v_cndmask_b32 v14, 0, v9, s[98:99]
    v_cndmask_b32 v36, 0, v11, s[100:101]
    v_or_b32 v14, v14, v36
    v_cmp_le_i32 s[98:99], 10, v248
    v_cmp_le_i32 s[100:101], 11, v248
    s_nop 0
    v_cndmask_b32 v15, 0, v9, s[98:99]
    v_cndmask_b32 v36, 0, v11, s[100:101]
    v_or_b32 v15, v15, v36
    v_cmp_le_i32 s[98:99], 16, v248
    v_cmp_le_i32 s[100:101], 17, v248
    s_nop 0
    v_cndmask_b32 v16, 0, v9, s[98:99]
    v_cndmask_b32 v36, 0, v11, s[100:101]
    v_or_b32 v16, v16, v36
    v_cmp_le_i32 s[98:99], 18, v248
    v_cmp_le_i32 s[100:101], 19, v248
    s_nop 0
    v_cndmask_b32 v17, 0, v9, s[98:99]
    v_cndmask_b32 v36, 0, v11, s[100:101]
    v_or_b32 v17, v17, v36
    v_cmp_le_i32 s[98:99], 24, v248
    v_cmp_le_i32 s[100:101], 25, v248
    s_nop 0
    v_cndmask_b32 v18, 0, v9, s[98:99]
    v_cndmask_b32 v36, 0, v11, s[100:101]
    v_or_b32 v18, v18, v36
    v_cmp_le_i32 s[98:99], 26, v248
    v_cmp_le_i32 s[100:101], 27, v248
    s_nop 0
    v_cndmask_b32 v19, 0, v9, s[98:99]
    v_cndmask_b32 v36, 0, v11, s[100:101]
    v_or_b32 v19, v19, v36
    s_lshl_b32 s48, s79, 8
    s_mul_i32 s51, s78, 15520
    s_add_u32 s50, s48, s51
    s_add_u32 s50, s50, 98304
    v_lshlrev_b32 v8, 3, v6
    v_add_u32 v8, s50, v8
    s_movk_i32 s49, 6208
    v_mul_lo_u32 v9, v7, s49
    v_add_u32 v3, v8, v9
    v_add_u32 v5, 12416, v8
    v_bfe_u32 v8, v1, 4, 1
    v_and_b32 v9, 3, v1
    v_lshl_add_u32 v8, v8, 2, v9
    v_bfe_u32 v9, v1, 2, 2
    v_lshl_add_u32 v9, v7, 2, v9
    v_lshlrev_b32 v9, 3, v9
    v_add_u32 v9, s48, v9
    s_movk_i32 s49, 3104
    v_mul_lo_u32 v11, v8, s49
    v_cmp_gt_u32 s[52:53], 5, v8
    s_add_u32 s51, s51, 129344
    s_sub_u32 s50, s51, 160384
    v_lshlrev_b32 v28, 5, v8
    v_add_u32 v28, s50, v28
    v_and_b32 v28, 255, v28
    v_add_u32 v28, 160384, v28
    v_add_u32 v29, s51, v11
    v_cndmask_b32 v28, v28, v29, s[52:53]
    v_add_u32 v4, v28, v9
    v_mov_b32 v96, 0x3ea52b5c
    v_mov_b32 v34, 0
    v_mov_b32 v35, 0
    v_mov_b32 v42, 0
    v_mov_b32 v43, 0
    v_mov_b32 v26, 0
    v_mov_b32 v27, 0
    v_lshlrev_b32 v10, 4, v1
    s_lshl_b32 s48, s88, 2
    s_add_u32 s61, s48, s79
    s_mul_i32 s48, s78, 5120
    s_lshl_b32 s49, s79, 8
    s_add_u32 s48, s48, s49
    s_add_u32 s48, s48, 81920
    v_lshlrev_b32 v8, 3, v6
    v_add_u32 v8, s48, v8
    v_lshl_add_u32 v9, v7, 11, v8
    s_waitcnt lgkmcnt(0)
    s_barrier
    ds_read_b64 v[20:21], v9
    ds_read_b64 v[22:23], v9 offset:1024
    ds_read_b64 v[24:25], v8 offset:4096
    v_cmp_gt_u32 s[52:53], 32, v1
    s_waitcnt lgkmcnt(0)
    s_nop 0
    v_cndmask_b32 v24, 0, v24, s[52:53]
    v_cndmask_b32 v25, 0, v25, s[52:53]
    v_mov_b32 v26, 0x3f80
    v_cndmask_b32 v26, 0, v26, s[52:53]
    ds_read_b64 v[28:29], v3 offset:0
    ds_read_b64 v[30:31], v3 offset:3104
    ds_read_b64 v[32:33], v5 offset:0
    s_cmp_lt_u32 s61, 8
    s_cselect_b32 s48, 0xf149, 0
    v_mov_b32 v34, s48
    ds_read_b64 v[36:37], v3 offset:2048
    ds_read_b64 v[38:39], v3 offset:5152
    ds_read_b64 v[40:41], v5 offset:2048
    v_mov_b32 v42, 0
    s_waitcnt lgkmcnt(3)
    v_mfma_f32_32x32x16_bf16 v[100:115], v[28:31], v[20:23], 0
    v_mfma_f32_32x32x16_bf16 v[100:115], v[32:35], v[24:27], v[100:115]
    ds_read_b64 v[28:29], v3 offset:256
    ds_read_b64 v[30:31], v3 offset:3360
    ds_read_b64 v[32:33], v5 offset:256
    s_cmp_lt_u32 s61, 7
    s_cselect_b32 s48, 0xf149, 0
    v_mov_b32 v34, s48
    s_waitcnt lgkmcnt(3)
    v_mfma_f32_32x32x16_bf16 v[116:131], v[36:39], v[20:23], 0
    v_mfma_f32_32x32x16_bf16 v[116:131], v[40:43], v[24:27], v[116:131]
    ds_read_b64 v[36:37], v3 offset:512
    ds_read_b64 v[38:39], v3 offset:3616
    ds_read_b64 v[40:41], v5 offset:512
    s_cmp_lt_u32 s61, 6
    s_cselect_b32 s48, 0xf149, 0
    v_mov_b32 v42, s48
    s_waitcnt lgkmcnt(3)
    v_mfma_f32_32x32x16_bf16 v[132:147], v[28:31], v[20:23], 0
    v_mfma_f32_32x32x16_bf16 v[132:147], v[32:35], v[24:27], v[132:147]
    v_cmp_le_i32 s[98:99], 0, v248
    v_cmp_le_i32 s[100:101], 1, v248
    s_nop 0
    v_cndmask_b32 v100, v100, v116, s[98:99]
    v_cndmask_b32 v101, v101, v117, s[100:101]
    v_cmp_le_i32 s[98:99], 2, v248
    v_cmp_le_i32 s[100:101], 3, v248
    s_nop 0
    v_cndmask_b32 v102, v102, v118, s[98:99]
    v_cndmask_b32 v103, v103, v119, s[100:101]
    v_cmp_le_i32 s[98:99], 8, v248
    v_cmp_le_i32 s[100:101], 9, v248
    s_nop 0
    v_cndmask_b32 v104, v104, v120, s[98:99]
    v_cndmask_b32 v105, v105, v121, s[100:101]
    v_cmp_le_i32 s[98:99], 10, v248
    v_cmp_le_i32 s[100:101], 11, v248
    s_nop 0
    v_cndmask_b32 v106, v106, v122, s[98:99]
    v_cndmask_b32 v107, v107, v123, s[100:101]
    v_cmp_le_i32 s[98:99], 16, v248
    v_cmp_le_i32 s[100:101], 17, v248
    s_nop 0
    v_cndmask_b32 v108, v108, v124, s[98:99]
    v_cndmask_b32 v109, v109, v125, s[100:101]
    v_cmp_le_i32 s[98:99], 18, v248
    v_cmp_le_i32 s[100:101], 19, v248
    s_nop 0
    v_cndmask_b32 v110, v110, v126, s[98:99]
    v_cndmask_b32 v111, v111, v127, s[100:101]
    v_cmp_le_i32 s[98:99], 24, v248
    v_cmp_le_i32 s[100:101], 25, v248
    s_nop 0
    v_cndmask_b32 v112, v112, v128, s[98:99]
    v_cndmask_b32 v113, v113, v129, s[100:101]
    v_cmp_le_i32 s[98:99], 26, v248
    v_cmp_le_i32 s[100:101], 27, v248
    s_nop 0
    v_cndmask_b32 v114, v114, v130, s[98:99]
    v_cndmask_b32 v115, v115, v131, s[100:101]
    v_max3_f32 v98, v100, v101, v102
    v_max3_f32 v98, v98, v103, v104
    v_max3_f32 v98, v98, v105, v106
    v_max_f32 v98, v98, v107
    v_max3_f32 v99, v108, v109, v110
    v_max3_f32 v99, v99, v111, v112
    v_max3_f32 v99, v99, v113, v114
    v_max_f32 v99, v99, v115
    ds_read_b64 v[28:29], v3 offset:768
    ds_read_b64 v[30:31], v3 offset:3872
    ds_read_b64 v[32:33], v5 offset:768
    s_cmp_lt_u32 s61, 5
    s_cselect_b32 s48, 0xf149, 0
    v_mov_b32 v34, s48
    s_waitcnt lgkmcnt(3)
    v_mfma_f32_32x32x16_bf16 v[116:131], v[36:39], v[20:23], 0
    v_mfma_f32_32x32x16_bf16 v[116:131], v[40:43], v[24:27], v[116:131]
    v_max3_f32 v98, v132, v133, v98
    v_max3_f32 v98, v98, v134, v135
    v_max3_f32 v98, v98, v136, v137
    v_max3_f32 v98, v98, v138, v139
    v_max3_f32 v99, v140, v141, v99
    v_max3_f32 v99, v99, v142, v143
    v_max3_f32 v99, v99, v144, v145
    v_max3_f32 v99, v99, v146, v147
    ds_read_b64 v[36:37], v3 offset:1024
    ds_read_b64 v[38:39], v3 offset:4128
    ds_read_b64 v[40:41], v5 offset:1024
    s_cmp_lt_u32 s61, 4
    s_cselect_b32 s48, 0xf149, 0
    v_mov_b32 v42, s48
    s_waitcnt lgkmcnt(3)
    v_mfma_f32_32x32x16_bf16 v[100:115], v[28:31], v[20:23], 0
    v_mfma_f32_32x32x16_bf16 v[100:115], v[32:35], v[24:27], v[100:115]
    v_max3_f32 v98, v116, v117, v98
    v_max3_f32 v98, v98, v118, v119
    v_max3_f32 v98, v98, v120, v121
    v_max3_f32 v98, v98, v122, v123
    v_max3_f32 v99, v124, v125, v99
    v_max3_f32 v99, v99, v126, v127
    v_max3_f32 v99, v99, v128, v129
    v_max3_f32 v99, v99, v130, v131
    ds_read_b64 v[28:29], v3 offset:1280
    ds_read_b64 v[30:31], v3 offset:4384
    ds_read_b64 v[32:33], v5 offset:1280
    s_cmp_lt_u32 s61, 3
    s_cselect_b32 s48, 0xf149, 0
    v_mov_b32 v34, s48
    s_waitcnt lgkmcnt(3)
    v_mfma_f32_32x32x16_bf16 v[132:147], v[36:39], v[20:23], 0
    v_mfma_f32_32x32x16_bf16 v[132:147], v[40:43], v[24:27], v[132:147]
    v_max3_f32 v98, v100, v101, v98
    v_max3_f32 v98, v98, v102, v103
    v_max3_f32 v98, v98, v104, v105
    v_max3_f32 v98, v98, v106, v107
    v_max3_f32 v99, v108, v109, v99
    v_max3_f32 v99, v99, v110, v111
    v_max3_f32 v99, v99, v112, v113
    v_max3_f32 v99, v99, v114, v115
    ds_read_b64 v[36:37], v3 offset:1536
    ds_read_b64 v[38:39], v3 offset:4640
    ds_read_b64 v[40:41], v5 offset:1536
    s_cmp_lt_u32 s61, 2
    s_cselect_b32 s48, 0xf149, 0
    v_mov_b32 v42, s48
    s_waitcnt lgkmcnt(3)
    v_mfma_f32_32x32x16_bf16 v[116:131], v[28:31], v[20:23], 0
    v_mfma_f32_32x32x16_bf16 v[116:131], v[32:35], v[24:27], v[116:131]
    v_max3_f32 v98, v132, v133, v98
    v_max3_f32 v98, v98, v134, v135
    v_max3_f32 v98, v98, v136, v137
    v_max3_f32 v98, v98, v138, v139
    v_max3_f32 v99, v140, v141, v99
    v_max3_f32 v99, v99, v142, v143
    v_max3_f32 v99, v99, v144, v145
    v_max3_f32 v99, v99, v146, v147
    ds_read_b64 v[28:29], v3 offset:1792
    ds_read_b64 v[30:31], v3 offset:4896
    ds_read_b64 v[32:33], v5 offset:1792
    s_cmp_lt_u32 s61, 1
    s_cselect_b32 s48, 0xf149, 0
    v_mov_b32 v34, s48
    s_waitcnt lgkmcnt(3)
    v_mfma_f32_32x32x16_bf16 v[100:115], v[36:39], v[20:23], 0
    v_mfma_f32_32x32x16_bf16 v[100:115], v[40:43], v[24:27], v[100:115]
    v_max3_f32 v98, v116, v117, v98
    v_max3_f32 v98, v98, v118, v119
    v_max3_f32 v98, v98, v120, v121
    v_max3_f32 v98, v98, v122, v123
    v_max3_f32 v99, v124, v125, v99
    v_max3_f32 v99, v99, v126, v127
    v_max3_f32 v99, v99, v128, v129
    v_max3_f32 v99, v99, v130, v131
    s_waitcnt lgkmcnt(0)
    v_mfma_f32_32x32x16_bf16 v[132:147], v[28:31], v[20:23], 0
    v_mfma_f32_32x32x16_bf16 v[132:147], v[32:35], v[24:27], v[132:147]
    s_nop 0
    v_max3_f32 v98, v100, v101, v98
    v_max3_f32 v98, v98, v102, v103
    v_max3_f32 v98, v98, v104, v105
    v_max3_f32 v98, v98, v106, v107
    v_max3_f32 v99, v108, v109, v99
    v_max3_f32 v99, v99, v110, v111
    v_max3_f32 v99, v99, v112, v113
    v_max3_f32 v99, v99, v114, v115
    s_nop 2
    v_max3_f32 v98, v132, v133, v98
    v_max3_f32 v98, v98, v134, v135
    v_max3_f32 v98, v98, v136, v137
    v_max3_f32 v98, v98, v138, v139
    v_max3_f32 v99, v140, v141, v99
    v_max3_f32 v99, v99, v142, v143
    v_max3_f32 v99, v99, v144, v145
    v_max3_f32 v99, v99, v146, v147
    v_max_f32 v98, v98, v99
    v_mov_b32 v99, v98
    s_nop 1
    v_permlane32_swap_b32 v98, v99
    v_max_f32 v98, v98, v99
    v_sub_f32 v148, 0, v98
    v_mov_b32 v149, v148
    v_mov_b32 v150, v148
    v_mov_b32 v151, v148
    v_mov_b32 v152, v148
    v_mov_b32 v153, v148
    v_mov_b32 v154, v148
    v_mov_b32 v155, v148
    v_mov_b32 v156, v148
    v_mov_b32 v157, v148
    v_mov_b32 v158, v148
    v_mov_b32 v159, v148
    v_mov_b32 v160, v148
    v_mov_b32 v161, v148
    v_mov_b32 v162, v148
    v_mov_b32 v163, v148
    ds_read_b64 v[36:37], v3 offset:0
    ds_read_b64 v[38:39], v3 offset:3104
    ds_read_b64 v[40:41], v5 offset:0
    s_cmp_lt_u32 s61, 8
    s_cselect_b32 s48, 0xf149, 0
    v_mov_b32 v42, s48
    ds_read_b64 v[28:29], v3 offset:2048
    ds_read_b64 v[30:31], v3 offset:5152
    ds_read_b64 v[32:33], v5 offset:2048
    v_mov_b32 v34, 0
    s_cmp_ge_u32 s44, 4
    s_cbranch_scc1 vb_17_1
    s_waitcnt vmcnt(0)
vb_17_1:
    s_waitcnt vmcnt(0)
    s_barrier
    v_mov_b32 v9, s96
    buffer_store_dword v9, v250, s[36:39], s86 offen sc1
    s_add_u32 m0, s75, 0
    s_add_u32 s77, s76, 0
    buffer_load_dwordx4 v10, s[36:39], s77 offen offset:0 sc1 lds
    buffer_load_dwordx4 v10, s[36:39], s77 offen offset:1024 sc1 lds
    buffer_load_dwordx4 v10, s[36:39], s77 offen offset:2048 sc1 lds
    buffer_load_dwordx4 v10, s[36:39], s77 offen offset:3072 sc1 lds
    s_add_u32 m0, m0, 4096
    s_add_u32 s77, s77, 4096
    buffer_load_dwordx4 v10, s[36:39], s77 offen sc1 lds
    s_add_u32 m0, s75, 40960
    s_add_u32 s77, s76, 40960
    buffer_load_dwordx4 v10, s[36:39], s77 offen offset:0 sc1 lds
    buffer_load_dwordx4 v10, s[36:39], s77 offen offset:1024 sc1 lds
    buffer_load_dwordx4 v10, s[36:39], s77 offen offset:2048 sc1 lds
    buffer_load_dwordx4 v10, s[36:39], s77 offen offset:3072 sc1 lds
    s_add_u32 m0, m0, 4096
    s_add_u32 s77, s77, 4096
    buffer_load_dwordx4 v10, s[36:39], s77 offen sc1 lds
    v_mov_b32 v76, 0
    v_mov_b32 v77, 0
    v_mov_b32 v78, 0
    v_mov_b32 v79, 0
    v_mov_b32 v80, 0
    v_mov_b32 v81, 0
    v_mov_b32 v82, 0
    v_mov_b32 v83, 0
    v_mov_b32 v84, 0
    v_mov_b32 v85, 0
    v_mov_b32 v86, 0
    v_mov_b32 v87, 0
    v_mov_b32 v88, 0
    v_mov_b32 v89, 0
    v_mov_b32 v90, 0
    v_mov_b32 v91, 0
    s_waitcnt lgkmcnt(3)
    v_mfma_f32_32x32x16_bf16 v[100:115], v[36:39], v[20:23], v[148:163]
    v_mfma_f32_32x32x16_bf16 v[100:115], v[40:43], v[24:27], v[100:115]
    ds_read_b64 v[36:37], v3 offset:256
    ds_read_b64 v[38:39], v3 offset:3360
    ds_read_b64 v[40:41], v5 offset:256
    s_cmp_lt_u32 s61, 7
    s_cselect_b32 s48, 0xf149, 0
    v_mov_b32 v42, s48
    s_waitcnt lgkmcnt(3)
    v_mfma_f32_32x32x16_bf16 v[116:131], v[28:31], v[20:23], v[148:163]
    v_mfma_f32_32x32x16_bf16 v[116:131], v[32:35], v[24:27], v[116:131]
    ds_read_b64 v[28:29], v3 offset:512
    ds_read_b64 v[30:31], v3 offset:3616
    ds_read_b64 v[32:33], v5 offset:512
    s_cmp_lt_u32 s61, 6
    s_cselect_b32 s48, 0xf149, 0
    v_mov_b32 v34, s48
    s_waitcnt lgkmcnt(3)
    v_mfma_f32_32x32x16_bf16 v[132:147], v[36:39], v[20:23], v[148:163]
    v_mfma_f32_32x32x16_bf16 v[132:147], v[40:43], v[24:27], v[132:147]
    v_cmp_le_i32 s[98:99], 0, v248
    v_cmp_le_i32 s[100:101], 1, v248
    s_nop 0
    v_cndmask_b32 v100, v100, v116, s[98:99]
    v_cndmask_b32 v101, v101, v117, s[100:101]
    v_cmp_le_i32 s[98:99], 2, v248
    v_cmp_le_i32 s[100:101], 3, v248
    s_nop 0
    v_cndmask_b32 v102, v102, v118, s[98:99]
    v_cndmask_b32 v103, v103, v119, s[100:101]
    v_cmp_le_i32 s[98:99], 8, v248
    v_cmp_le_i32 s[100:101], 9, v248
    s_nop 0
    v_cndmask_b32 v104, v104, v120, s[98:99]
    v_cndmask_b32 v105, v105, v121, s[100:101]
    v_cmp_le_i32 s[98:99], 10, v248
    v_cmp_le_i32 s[100:101], 11, v248
    s_nop 0
    v_cndmask_b32 v106, v106, v122, s[98:99]
    v_cndmask_b32 v107, v107, v123, s[100:101]
    v_cmp_le_i32 s[98:99], 16, v248
    v_cmp_le_i32 s[100:101], 17, v248
    s_nop 0
    v_cndmask_b32 v108, v108, v124, s[98:99]
    v_cndmask_b32 v109, v109, v125, s[100:101]
    v_cmp_le_i32 s[98:99], 18, v248
    v_cmp_le_i32 s[100:101], 19, v248
    s_nop 0
    v_cndmask_b32 v110, v110, v126, s[98:99]
    v_cndmask_b32 v111, v111, v127, s[100:101]
    v_cmp_le_i32 s[98:99], 24, v248
    v_cmp_le_i32 s[100:101], 25, v248
    s_nop 0
    v_cndmask_b32 v112, v112, v128, s[98:99]
    v_cndmask_b32 v113, v113, v129, s[100:101]
    v_cmp_le_i32 s[98:99], 26, v248
    v_cmp_le_i32 s[100:101], 27, v248
    s_nop 0
    v_cndmask_b32 v114, v114, v130, s[98:99]
    v_cndmask_b32 v115, v115, v131, s[100:101]
    ds_read_b64_tr_b16 v[44:45], v4 offset:0
    ds_read_b64_tr_b16 v[46:47], v4 offset:64
    ds_read_b64_tr_b16 v[48:49], v4 offset:2048
    ds_read_b64_tr_b16 v[50:51], v4 offset:2112
    v_exp_f32 v100, v100
    v_exp_f32 v101, v101
    v_exp_f32 v102, v102
    v_exp_f32 v103, v103
    v_exp_f32 v104, v104
    v_exp_f32 v105, v105
    v_exp_f32 v106, v106
    v_exp_f32 v107, v107
    v_cvt_pk_bf16_f32 v60, v100, v101
    v_cvt_pk_bf16_f32 v61, v102, v103
    v_cvt_pk_bf16_f32 v62, v104, v105
    v_cvt_pk_bf16_f32 v63, v106, v107
    v_and_b32 v64, v60, v12
    v_and_b32 v65, v61, v13
    v_and_b32 v66, v62, v14
    v_and_b32 v67, v63, v15
    v_xor_b32 v60, v60, v64
    v_xor_b32 v61, v61, v65
    v_xor_b32 v62, v62, v66
    v_xor_b32 v63, v63, v67
    s_waitcnt lgkmcnt(2)
    s_nop 0
    v_mfma_f32_32x32x16_bf16 v[76:91], v[44:47], v[60:63], v[76:91]
    s_waitcnt lgkmcnt(0)
    v_mfma_f32_32x32x16_bf16 v[76:91], v[48:51], v[64:67], v[76:91]
    ds_read_b64_tr_b16 v[52:53], v4 offset:128
    ds_read_b64_tr_b16 v[54:55], v4 offset:192
    ds_read_b64_tr_b16 v[56:57], v4 offset:2176
    ds_read_b64_tr_b16 v[58:59], v4 offset:2240
    v_exp_f32 v108, v108
    v_exp_f32 v109, v109
    v_exp_f32 v110, v110
    v_exp_f32 v111, v111
    v_exp_f32 v112, v112
    v_exp_f32 v113, v113
    v_exp_f32 v114, v114
    v_exp_f32 v115, v115
    v_cvt_pk_bf16_f32 v68, v108, v109
    v_cvt_pk_bf16_f32 v69, v110, v111
    v_cvt_pk_bf16_f32 v70, v112, v113
    v_cvt_pk_bf16_f32 v71, v114, v115
    v_and_b32 v72, v68, v16
    v_and_b32 v73, v69, v17
    v_and_b32 v74, v70, v18
    v_and_b32 v75, v71, v19
    v_xor_b32 v68, v68, v72
    v_xor_b32 v69, v69, v73
    v_xor_b32 v70, v70, v74
    v_xor_b32 v71, v71, v75
    s_waitcnt lgkmcnt(2)
    s_nop 0
    v_mfma_f32_32x32x16_bf16 v[76:91], v[52:55], v[68:71], v[76:91]
    s_waitcnt lgkmcnt(0)
    v_mfma_f32_32x32x16_bf16 v[76:91], v[56:59], v[72:75], v[76:91]
    ds_read_b64 v[36:37], v3 offset:768
    ds_read_b64 v[38:39], v3 offset:3872
    ds_read_b64 v[40:41], v5 offset:768
    s_cmp_lt_u32 s61, 5
    s_cselect_b32 s48, 0xf149, 0
    v_mov_b32 v42, s48
    v_mfma_f32_32x32x16_bf16 v[116:131], v[28:31], v[20:23], v[148:163]
    v_mfma_f32_32x32x16_bf16 v[116:131], v[32:35], v[24:27], v[116:131]
    ds_read_b64_tr_b16 v[44:45], v4 offset:256
    ds_read_b64_tr_b16 v[46:47], v4 offset:320
    v_exp_f32 v132, v132
    v_exp_f32 v133, v133
    v_exp_f32 v134, v134
    v_exp_f32 v135, v135
    v_exp_f32 v136, v136
    v_exp_f32 v137, v137
    v_exp_f32 v138, v138
    v_exp_f32 v139, v139
    v_cvt_pk_bf16_f32 v60, v132, v133
    v_cvt_pk_bf16_f32 v61, v134, v135
    v_cvt_pk_bf16_f32 v62, v136, v137
    v_cvt_pk_bf16_f32 v63, v138, v139
    s_waitcnt lgkmcnt(0)
    s_nop 0
    v_mfma_f32_32x32x16_bf16 v[76:91], v[44:47], v[60:63], v[76:91]
    ds_read_b64_tr_b16 v[48:49], v4 offset:384
    ds_read_b64_tr_b16 v[50:51], v4 offset:448
    v_exp_f32 v140, v140
    v_exp_f32 v141, v141
    v_exp_f32 v142, v142
    v_exp_f32 v143, v143
    v_exp_f32 v144, v144
    v_exp_f32 v145, v145
    v_exp_f32 v146, v146
    v_exp_f32 v147, v147
    v_cvt_pk_bf16_f32 v64, v140, v141
    v_cvt_pk_bf16_f32 v65, v142, v143
    v_cvt_pk_bf16_f32 v66, v144, v145
    v_cvt_pk_bf16_f32 v67, v146, v147
    s_waitcnt lgkmcnt(0)
    s_nop 0
    v_mfma_f32_32x32x16_bf16 v[76:91], v[48:51], v[64:67], v[76:91]
    ds_read_b64 v[28:29], v3 offset:1024
    ds_read_b64 v[30:31], v3 offset:4128
    ds_read_b64 v[32:33], v5 offset:1024
    s_cmp_lt_u32 s61, 4
    s_cselect_b32 s48, 0xf149, 0
    v_mov_b32 v34, s48
    v_mfma_f32_32x32x16_bf16 v[100:115], v[36:39], v[20:23], v[148:163]
    v_mfma_f32_32x32x16_bf16 v[100:115], v[40:43], v[24:27], v[100:115]
    ds_read_b64_tr_b16 v[52:53], v4 offset:512
    ds_read_b64_tr_b16 v[54:55], v4 offset:576
    v_exp_f32 v116, v116
    v_exp_f32 v117, v117
    v_exp_f32 v118, v118
    v_exp_f32 v119, v119
    v_exp_f32 v120, v120
    v_exp_f32 v121, v121
    v_exp_f32 v122, v122
    v_exp_f32 v123, v123
    v_cvt_pk_bf16_f32 v68, v116, v117
    v_cvt_pk_bf16_f32 v69, v118, v119
    v_cvt_pk_bf16_f32 v70, v120, v121
    v_cvt_pk_bf16_f32 v71, v122, v123
    s_waitcnt lgkmcnt(0)
    s_nop 0
    v_mfma_f32_32x32x16_bf16 v[76:91], v[52:55], v[68:71], v[76:91]
    ds_read_b64_tr_b16 v[56:57], v4 offset:640
    ds_read_b64_tr_b16 v[58:59], v4 offset:704
    v_exp_f32 v124, v124
    v_exp_f32 v125, v125
    v_exp_f32 v126, v126
    v_exp_f32 v127, v127
    v_exp_f32 v128, v128
    v_exp_f32 v129, v129
    v_exp_f32 v130, v130
    v_exp_f32 v131, v131
    v_cvt_pk_bf16_f32 v72, v124, v125
    v_cvt_pk_bf16_f32 v73, v126, v127
    v_cvt_pk_bf16_f32 v74, v128, v129
    v_cvt_pk_bf16_f32 v75, v130, v131
    s_waitcnt lgkmcnt(0)
    s_nop 0
    v_mfma_f32_32x32x16_bf16 v[76:91], v[56:59], v[72:75], v[76:91]
    buffer_load_dword v95, v94, s[36:39], 0 offen sc1
    ds_read_b64 v[36:37], v3 offset:1280
    ds_read_b64 v[38:39], v3 offset:4384
    ds_read_b64 v[40:41], v5 offset:1280
    s_cmp_lt_u32 s61, 3
    s_cselect_b32 s48, 0xf149, 0
    v_mov_b32 v42, s48
    v_mfma_f32_32x32x16_bf16 v[132:147], v[28:31], v[20:23], v[148:163]
    v_mfma_f32_32x32x16_bf16 v[132:147], v[32:35], v[24:27], v[132:147]
    ds_read_b64_tr_b16 v[44:45], v4 offset:768
    ds_read_b64_tr_b16 v[46:47], v4 offset:832
    v_exp_f32 v100, v100
    v_exp_f32 v101, v101
    v_exp_f32 v102, v102
    v_exp_f32 v103, v103
    v_exp_f32 v104, v104
    v_exp_f32 v105, v105
    v_exp_f32 v106, v106
    v_exp_f32 v107, v107
    v_cvt_pk_bf16_f32 v60, v100, v101
    v_cvt_pk_bf16_f32 v61, v102, v103
    v_cvt_pk_bf16_f32 v62, v104, v105
    v_cvt_pk_bf16_f32 v63, v106, v107
    s_waitcnt lgkmcnt(0)
    s_nop 0
    v_mfma_f32_32x32x16_bf16 v[76:91], v[44:47], v[60:63], v[76:91]
    ds_read_b64_tr_b16 v[48:49], v4 offset:896
    ds_read_b64_tr_b16 v[50:51], v4 offset:960
    v_exp_f32 v108, v108
    v_exp_f32 v109, v109
    v_exp_f32 v110, v110
    v_exp_f32 v111, v111
    v_exp_f32 v112, v112
    v_exp_f32 v113, v113
    v_exp_f32 v114, v114
    v_exp_f32 v115, v115
    v_cvt_pk_bf16_f32 v64, v108, v109
    v_cvt_pk_bf16_f32 v65, v110, v111
    v_cvt_pk_bf16_f32 v66, v112, v113
    v_cvt_pk_bf16_f32 v67, v114, v115
    s_waitcnt lgkmcnt(0)
    s_nop 0
    v_mfma_f32_32x32x16_bf16 v[76:91], v[48:51], v[64:67], v[76:91]
    ds_read_b64 v[28:29], v3 offset:1536
    ds_read_b64 v[30:31], v3 offset:4640
    ds_read_b64 v[32:33], v5 offset:1536
    s_cmp_lt_u32 s61, 2
    s_cselect_b32 s48, 0xf149, 0
    v_mov_b32 v34, s48
    v_mfma_f32_32x32x16_bf16 v[116:131], v[36:39], v[20:23], v[148:163]
    v_mfma_f32_32x32x16_bf16 v[116:131], v[40:43], v[24:27], v[116:131]
    ds_read_b64_tr_b16 v[52:53], v4 offset:1024
    ds_read_b64_tr_b16 v[54:55], v4 offset:1088
    v_exp_f32 v132, v132
    v_exp_f32 v133, v133
    v_exp_f32 v134, v134
    v_exp_f32 v135, v135
    v_exp_f32 v136, v136
    v_exp_f32 v137, v137
    v_exp_f32 v138, v138
    v_exp_f32 v139, v139
    v_cvt_pk_bf16_f32 v68, v132, v133
    v_cvt_pk_bf16_f32 v69, v134, v135
    v_cvt_pk_bf16_f32 v70, v136, v137
    v_cvt_pk_bf16_f32 v71, v138, v139
    s_waitcnt lgkmcnt(0)
    s_nop 0
    v_mfma_f32_32x32x16_bf16 v[76:91], v[52:55], v[68:71], v[76:91]
    ds_read_b64_tr_b16 v[56:57], v4 offset:1152
    ds_read_b64_tr_b16 v[58:59], v4 offset:1216
    v_exp_f32 v140, v140
    v_exp_f32 v141, v141
    v_exp_f32 v142, v142
    v_exp_f32 v143, v143
    v_exp_f32 v144, v144
    v_exp_f32 v145, v145
    v_exp_f32 v146, v146
    v_exp_f32 v147, v147
    v_cvt_pk_bf16_f32 v72, v140, v141
    v_cvt_pk_bf16_f32 v73, v142, v143
    v_cvt_pk_bf16_f32 v74, v144, v145
    v_cvt_pk_bf16_f32 v75, v146, v147
    s_waitcnt lgkmcnt(0)
    s_nop 0
    v_mfma_f32_32x32x16_bf16 v[76:91], v[56:59], v[72:75], v[76:91]
    s_and_b32 s72, s44, 3
    s_lshr_b32 s81, s44, 2
    s_waitcnt vmcnt(0)
    v_cmp_ne_u32 vcc, s96, v95
    s_nop 4
    s_cbranch_vccz pc_18_ok
pc_18:
    s_sleep 1
    buffer_load_dword v95, v94, s[36:39], 0 offen sc1
    s_waitcnt vmcnt(0)
    v_cmp_ne_u32 vcc, s96, v95
    s_nop 4
    s_cbranch_vccnz pc_18
pc_18_ok:
    v_lshrrev_b32 v6, 5, v1
    v_bfe_u32 v7, v1, 4, 1
    v_lshlrev_b32 v6, 10, v6
    v_lshl_add_u32 v6, v7, 9, v6
    v_and_b32 v7, 15, v1
    s_and_b32 s48, s72, 1
    s_lshl_b32 s48, s48, 4
    v_add_u32 v8, s48, v7
    v_lshl_add_u32 v11, v8, 4, v6
    s_lshl_b32 s48, s73, 1
    s_lshr_b32 s49, s72, 1
    s_add_u32 s48, s48, s49
    s_lshl_b32 s50, s81, 11
    s_mul_i32 s49, s48, 110592
    s_add_u32 s49, s49, s50
    s_add_u32 s70, s49, 11534336
    s_mul_i32 s49, s48, 40960
    s_add_u32 s49, s49, s50
    s_add_u32 s71, s49, 18874368
    ds_read_b64 v[36:37], v3 offset:1792
    ds_read_b64 v[38:39], v3 offset:4896
    ds_read_b64 v[40:41], v5 offset:1792
    s_cmp_lt_u32 s61, 1
    s_cselect_b32 s48, 0xf149, 0
    v_mov_b32 v42, s48
    v_mfma_f32_32x32x16_bf16 v[100:115], v[28:31], v[20:23], v[148:163]
    v_mfma_f32_32x32x16_bf16 v[100:115], v[32:35], v[24:27], v[100:115]
    ds_read_b64_tr_b16 v[44:45], v4 offset:1280
    ds_read_b64_tr_b16 v[46:47], v4 offset:1344
    v_exp_f32 v116, v116
    v_exp_f32 v117, v117
    v_exp_f32 v118, v118
    v_exp_f32 v119, v119
    v_exp_f32 v120, v120
    v_exp_f32 v121, v121
    v_exp_f32 v122, v122
    v_exp_f32 v123, v123
    v_cvt_pk_bf16_f32 v60, v116, v117
    v_cvt_pk_bf16_f32 v61, v118, v119
    v_cvt_pk_bf16_f32 v62, v120, v121
    v_cvt_pk_bf16_f32 v63, v122, v123
    s_waitcnt lgkmcnt(0)
    s_nop 0
    v_mfma_f32_32x32x16_bf16 v[76:91], v[44:47], v[60:63], v[76:91]
    buffer_load_dwordx4 v[164:167], v11, s[36:39], s70 offen sc1
    s_add_u32 s70, s70, 4096
    buffer_load_dwordx4 v[168:171], v11, s[36:39], s70 offen sc1
    s_add_u32 s70, s70, 4096
    buffer_load_dwordx4 v[172:175], v11, s[36:39], s70 offen sc1
    ds_read_b64_tr_b16 v[48:49], v4 offset:1408
    ds_read_b64_tr_b16 v[50:51], v4 offset:1472
    v_exp_f32 v124, v124
    v_exp_f32 v125, v125
    v_exp_f32 v126, v126
    v_exp_f32 v127, v127
    v_exp_f32 v128, v128
    v_exp_f32 v129, v129
    v_exp_f32 v130, v130
    v_exp_f32 v131, v131
    v_cvt_pk_bf16_f32 v64, v124, v125
    v_cvt_pk_bf16_f32 v65, v126, v127
    v_cvt_pk_bf16_f32 v66, v128, v129
    v_cvt_pk_bf16_f32 v67, v130, v131
    s_waitcnt lgkmcnt(0)
    s_nop 0
    v_mfma_f32_32x32x16_bf16 v[76:91], v[48:51], v[64:67], v[76:91]
    s_add_u32 s70, s70, 4096
    buffer_load_dwordx4 v[176:179], v11, s[36:39], s70 offen sc1
    s_add_u32 s70, s70, 4096
    buffer_load_dwordx4 v[180:183], v11, s[36:39], s70 offen sc1
    s_add_u32 s70, s70, 4096
    buffer_load_dwordx4 v[184:187], v11, s[36:39], s70 offen sc1
    v_mfma_f32_32x32x16_bf16 v[132:147], v[36:39], v[20:23], v[148:163]
    v_mfma_f32_32x32x16_bf16 v[132:147], v[40:43], v[24:27], v[132:147]
    ds_read_b64_tr_b16 v[52:53], v4 offset:1536
    ds_read_b64_tr_b16 v[54:55], v4 offset:1600
    v_exp_f32 v100, v100
    v_exp_f32 v101, v101
    v_exp_f32 v102, v102
    v_exp_f32 v103, v103
    v_exp_f32 v104, v104
    v_exp_f32 v105, v105
    v_exp_f32 v106, v106
    v_exp_f32 v107, v107
    v_cvt_pk_bf16_f32 v68, v100, v101
    v_cvt_pk_bf16_f32 v69, v102, v103
    v_cvt_pk_bf16_f32 v70, v104, v105
    v_cvt_pk_bf16_f32 v71, v106, v107
    s_waitcnt lgkmcnt(0)
    s_nop 0
    v_mfma_f32_32x32x16_bf16 v[76:91], v[52:55], v[68:71], v[76:91]
    s_add_u32 s70, s70, 4096
    buffer_load_dwordx4 v[188:191], v11, s[36:39], s70 offen sc1
    s_add_u32 s70, s70, 4096
    buffer_load_dwordx4 v[192:195], v11, s[36:39], s70 offen sc1
    s_add_u32 s70, s70, 4096
    buffer_load_dwordx4 v[196:199], v11, s[36:39], s70 offen sc1
    ds_read_b64_tr_b16 v[56:57], v4 offset:1664
    ds_read_b64_tr_b16 v[58:59], v4 offset:1728
    v_exp_f32 v108, v108
    v_exp_f32 v109, v109
    v_exp_f32 v110, v110
    v_exp_f32 v111, v111
    v_exp_f32 v112, v112
    v_exp_f32 v113, v113
    v_exp_f32 v114, v114
    v_exp_f32 v115, v115
    v_cvt_pk_bf16_f32 v72, v108, v109
    v_cvt_pk_bf16_f32 v73, v110, v111
    v_cvt_pk_bf16_f32 v74, v112, v113
    v_cvt_pk_bf16_f32 v75, v114, v115
    s_waitcnt lgkmcnt(0)
    s_nop 0
    v_mfma_f32_32x32x16_bf16 v[76:91], v[56:59], v[72:75], v[76:91]
    s_add_u32 s70, s70, 4096
    buffer_load_dwordx4 v[200:203], v11, s[36:39], s70 offen sc1
    s_add_u32 s70, s70, 4096
    buffer_load_dwordx4 v[204:207], v11, s[36:39], s70 offen sc1
    s_add_u32 s70, s70, 4096
    buffer_load_dwordx4 v[208:211], v11, s[36:39], s70 offen sc1
    ds_read_b64_tr_b16 v[44:45], v4 offset:1792
    ds_read_b64_tr_b16 v[46:47], v4 offset:1856
    v_exp_f32 v132, v132
    v_exp_f32 v133, v133
    v_exp_f32 v134, v134
    v_exp_f32 v135, v135
    v_exp_f32 v136, v136
    v_exp_f32 v137, v137
    v_exp_f32 v138, v138
    v_exp_f32 v139, v139
    v_cvt_pk_bf16_f32 v60, v132, v133
    v_cvt_pk_bf16_f32 v61, v134, v135
    v_cvt_pk_bf16_f32 v62, v136, v137
    v_cvt_pk_bf16_f32 v63, v138, v139
    s_waitcnt lgkmcnt(0)
    s_nop 0
    v_mfma_f32_32x32x16_bf16 v[76:91], v[44:47], v[60:63], v[76:91]
    s_add_u32 s70, s70, 4096
    buffer_load_dwordx4 v[212:215], v11, s[36:39], s70 offen sc1
    s_add_u32 s70, s70, 4096
    buffer_load_dwordx4 v[216:219], v11, s[36:39], s70 offen sc1
    ds_read_b64_tr_b16 v[48:49], v4 offset:1920
    ds_read_b64_tr_b16 v[50:51], v4 offset:1984
    v_exp_f32 v140, v140
    v_exp_f32 v141, v141
    v_exp_f32 v142, v142
    v_exp_f32 v143, v143
    v_exp_f32 v144, v144
    v_exp_f32 v145, v145
    v_exp_f32 v146, v146
    v_exp_f32 v147, v147
    v_cvt_pk_bf16_f32 v64, v140, v141
    v_cvt_pk_bf16_f32 v65, v142, v143
    v_cvt_pk_bf16_f32 v66, v144, v145
    v_cvt_pk_bf16_f32 v67, v146, v147
    s_waitcnt lgkmcnt(0)
    s_nop 0
    v_mfma_f32_32x32x16_bf16 v[76:91], v[48:51], v[64:67], v[76:91]
    s_add_u32 s70, s70, 4096
    buffer_load_dwordx4 v[220:223], v11, s[36:39], s70 offen sc1
    s_add_u32 s70, s70, 4096
    buffer_load_dwordx4 v[224:227], v11, s[36:39], s70 offen sc1
    v_and_b32 v6, 1, v1
    v_mul_u32_u24 v6, 40960, v6
    v_bfe_u32 v7, v1, 1, 4
    v_lshl_add_u32 v6, v7, 4, v6
    s_and_b32 s48, s61, 1
    s_lshl_b32 s48, s48, 8
    s_lshr_b32 s49, s61, 1
    s_mul_i32 s49, s49, 81920
    s_add_u32 s48, s48, s49
    s_add_u32 s48, s48, 18874368
    v_lshrrev_b32 v7, 5, v1
    v_lshl_add_u32 v8, v7, 9, v6
    v_rcp_f32 v97, v88
    s_nop 0
    v_mul_f32 v76, v76, v97
    v_mul_f32 v77, v77, v97
    v_mul_f32 v78, v78, v97
    v_mul_f32 v79, v79, v97
    v_mul_f32 v80, v80, v97
    v_mul_f32 v81, v81, v97
    v_mul_f32 v82, v82, v97
    v_mul_f32 v83, v83, v97
    v_mul_f32 v84, v84, v97
    v_mul_f32 v85, v85, v97
    v_mul_f32 v86, v86, v97
    v_mul_f32 v87, v87, v97
    v_cvt_pk_bf16_f32 v60, v76, v77
    v_cvt_pk_bf16_f32 v61, v78, v79
    v_cvt_pk_bf16_f32 v62, v80, v81
    v_cvt_pk_bf16_f32 v63, v82, v83
    v_cvt_pk_bf16_f32 v64, v84, v85
    v_cvt_pk_bf16_f32 v65, v86, v87
    s_lshl_b32 s49, s89, 1
    s_add_u32 s49, s49, s78
    s_lshl_b32 s49, s49, 10
    s_add_u32 s49, s49, s48
    buffer_store_dwordx4 v[60:63], v8, s[36:39], s49 offen sc1
    s_lshr_b32 s49, s89, 1
    s_add_u32 s49, s49, 32
    s_lshl_b32 s49, s49, 10
    s_and_b32 s50, s89, 1
    s_lshl_b32 s50, s50, 9
    s_add_u32 s49, s49, s50
    s_lshl_b32 s50, s78, 3
    s_add_u32 s49, s49, s50
    s_add_u32 s49, s49, s48
    s_mov_b32 exec_hi, 0
    buffer_store_dwordx2 v[64:65], v6, s[36:39], s49 offen sc1
    s_mov_b32 exec_hi, -1
    s_lshl_b32 s48, s88, 7
    s_lshl_b32 s49, s89, 2
    s_add_u32 s48, s48, s49
    s_add_u32 s78, s48, 25172992
    s_mov_b32 s28, s18
    s_and_b32 s29, s19, 0xffff
    s_mov_b32 s30, 1280
    s_mov_b32 s31, 0x20000
    s_mov_b32 s32, s22
    s_and_b32 s33, s23, 0xffff
    s_mov_b32 s34, 2621440
    s_mov_b32 s35, 0x20000
    s_mul_i32 s48, s81, 5120
    v_lshlrev_b32 v17, 4, v1
    v_add_u32 v17, s48, v17
    v_add_u32 v12, 0, v17
    v_add_u32 v13, 40960, v17
    v_add_u32 v14, 81920, v17
    v_add_u32 v15, 122880, v17
    s_barrier
    ds_read_b128 v[20:23], v12 offset:0
    ds_read_b128 v[24:27], v12 offset:1024
    ds_read_b128 v[28:31], v12 offset:2048
    ds_read_b128 v[32:35], v12 offset:3072
    ds_read_b128 v[36:39], v12 offset:4096
    ds_read_b128 v[40:43], v12 offset:10240
    ds_read_b128 v[44:47], v12 offset:11264
    ds_read_b128 v[48:51], v12 offset:12288
    ds_read_b128 v[52:55], v12 offset:13312
    ds_read_b128 v[56:59], v12 offset:14336
    s_lshr_b32 s48, s73, 1
    s_lshl_b32 s48, s48, 7
    s_add_u32 s48, s48, 25172992
    v_and_b32 v6, 15, v1
    v_lshlrev_b32 v6, 2, v6
    v_add_u32 v6, s48, v6
    s_waitcnt vmcnt(17)
    s_waitcnt lgkmcnt(9)
    v_mfma_f32_16x16x32_bf16 v[100:103], v[20:23], v[164:167], 0
    ds_read_b128 v[60:63], v12 offset:20480
    s_waitcnt lgkmcnt(9)
    v_mfma_f32_16x16x32_bf16 v[104:107], v[24:27], v[164:167], 0
    ds_read_b128 v[64:67], v12 offset:21504
    s_add_u32 s70, s70, 4096
    buffer_load_dwordx4 v[228:231], v11, s[36:39], s70 offen sc1
    s_waitcnt lgkmcnt(9)
    v_mfma_f32_16x16x32_bf16 v[108:111], v[28:31], v[164:167], 0
    ds_read_b128 v[68:71], v12 offset:22528
    s_waitcnt lgkmcnt(9)
    v_mfma_f32_16x16x32_bf16 v[112:115], v[32:35], v[164:167], 0
    ds_read_b128 v[72:75], v12 offset:23552
    s_waitcnt lgkmcnt(9)
    v_mfma_f32_16x16x32_bf16 v[116:119], v[36:39], v[164:167], 0
    ds_read_b128 v[76:79], v12 offset:24576
    s_add_u32 m0, s75, 81920
    s_add_u32 s77, s76, 81920
    buffer_load_dwordx4 v10, s[36:39], s77 offen offset:0 sc1 lds
    buffer_load_dwordx4 v10, s[36:39], s77 offen offset:1024 sc1 lds
    buffer_load_dwordx4 v10, s[36:39], s77 offen offset:2048 sc1 lds
    buffer_load_dwordx4 v10, s[36:39], s77 offen offset:3072 sc1 lds
    s_add_u32 m0, m0, 4096
    s_add_u32 s77, s77, 4096
    buffer_load_dwordx4 v10, s[36:39], s77 offen sc1 lds
    s_waitcnt vmcnt(22)
    s_waitcnt lgkmcnt(9)
    v_mfma_f32_16x16x32_bf16 v[100:103], v[40:43], v[168:171], v[100:103]
    ds_read_b128 v[20:23], v12 offset:30720
    s_waitcnt lgkmcnt(9)
    v_mfma_f32_16x16x32_bf16 v[104:107], v[44:47], v[168:171], v[104:107]
    ds_read_b128 v[24:27], v12 offset:31744
    s_add_u32 s70, s70, 4096
    buffer_load_dwordx4 v[232:235], v11, s[36:39], s70 offen sc1
    s_waitcnt lgkmcnt(9)
    v_mfma_f32_16x16x32_bf16 v[108:111], v[48:51], v[168:171], v[108:111]
    ds_read_b128 v[28:31], v12 offset:32768
    s_waitcnt lgkmcnt(9)
    v_mfma_f32_16x16x32_bf16 v[112:115], v[52:55], v[168:171], v[112:115]
    ds_read_b128 v[32:35], v12 offset:33792
    s_waitcnt lgkmcnt(9)
    v_mfma_f32_16x16x32_bf16 v[116:119], v[56:59], v[168:171], v[116:119]
    ds_read_b128 v[36:39], v12 offset:34816
    s_waitcnt vmcnt(7)
    s_barrier
    v_mov_b32 v17, s96
    buffer_store_dword v17, v250, s[36:39], s78 offen sc1
    s_add_u32 m0, s75, 122880
    s_add_u32 s77, s76, 122880
    buffer_load_dwordx4 v10, s[36:39], s77 offen offset:0 sc1 lds
    buffer_load_dwordx4 v10, s[36:39], s77 offen offset:1024 sc1 lds
    buffer_load_dwordx4 v10, s[36:39], s77 offen offset:2048 sc1 lds
    buffer_load_dwordx4 v10, s[36:39], s77 offen offset:3072 sc1 lds
    s_add_u32 m0, m0, 4096
    s_add_u32 s77, s77, 4096
    buffer_load_dwordx4 v10, s[36:39], s77 offen sc1 lds
    s_waitcnt lgkmcnt(9)
    v_mfma_f32_16x16x32_bf16 v[100:103], v[60:63], v[172:175], v[100:103]
    ds_read_b128 v[40:43], v13 offset:0
    s_waitcnt lgkmcnt(9)
    v_mfma_f32_16x16x32_bf16 v[104:107], v[64:67], v[172:175], v[104:107]
    ds_read_b128 v[44:47], v13 offset:1024
    s_add_u32 s70, s70, 4096
    buffer_load_dwordx4 v[236:239], v11, s[36:39], s70 offen sc1
    s_waitcnt lgkmcnt(9)
    v_mfma_f32_16x16x32_bf16 v[108:111], v[68:71], v[172:175], v[108:111]
    ds_read_b128 v[48:51], v13 offset:2048
    s_waitcnt lgkmcnt(9)
    v_mfma_f32_16x16x32_bf16 v[112:115], v[72:75], v[172:175], v[112:115]
    ds_read_b128 v[52:55], v13 offset:3072
    s_waitcnt lgkmcnt(9)
    v_mfma_f32_16x16x32_bf16 v[116:119], v[76:79], v[172:175], v[116:119]
    ds_read_b128 v[56:59], v13 offset:4096
    s_waitcnt lgkmcnt(9)
    v_mfma_f32_16x16x32_bf16 v[100:103], v[20:23], v[176:179], v[100:103]
    ds_read_b128 v[60:63], v13 offset:10240
    s_waitcnt lgkmcnt(9)
    v_mfma_f32_16x16x32_bf16 v[104:107], v[24:27], v[176:179], v[104:107]
    ds_read_b128 v[64:67], v13 offset:11264
    s_add_u32 s70, s70, 4096
    buffer_load_dwordx4 v[240:243], v11, s[36:39], s70 offen sc1
    s_waitcnt lgkmcnt(9)
    v_mfma_f32_16x16x32_bf16 v[108:111], v[28:31], v[176:179], v[108:111]
    ds_read_b128 v[68:71], v13 offset:12288
    s_waitcnt lgkmcnt(9)
    v_mfma_f32_16x16x32_bf16 v[112:115], v[32:35], v[176:179], v[112:115]
    ds_read_b128 v[72:75], v13 offset:13312
    s_waitcnt lgkmcnt(9)
    v_mfma_f32_16x16x32_bf16 v[116:119], v[36:39], v[176:179], v[116:119]
    ds_read_b128 v[76:79], v13 offset:14336
    s_waitcnt lgkmcnt(9)
    v_mfma_f32_16x16x32_bf16 v[100:103], v[40:43], v[180:183], v[100:103]
    ds_read_b128 v[20:23], v13 offset:20480
    s_waitcnt lgkmcnt(9)
    v_mfma_f32_16x16x32_bf16 v[104:107], v[44:47], v[180:183], v[104:107]
    ds_read_b128 v[24:27], v13 offset:21504
    s_add_u32 s70, s70, 4096
    buffer_load_dwordx4 v[164:167], v11, s[36:39], s70 offen sc1
    s_waitcnt lgkmcnt(9)
    v_mfma_f32_16x16x32_bf16 v[108:111], v[48:51], v[180:183], v[108:111]
    ds_read_b128 v[28:31], v13 offset:22528
    s_waitcnt lgkmcnt(9)
    v_mfma_f32_16x16x32_bf16 v[112:115], v[52:55], v[180:183], v[112:115]
    ds_read_b128 v[32:35], v13 offset:23552
    s_waitcnt lgkmcnt(9)
    v_mfma_f32_16x16x32_bf16 v[116:119], v[56:59], v[180:183], v[116:119]
    ds_read_b128 v[36:39], v13 offset:24576
    s_waitcnt lgkmcnt(9)
    v_mfma_f32_16x16x32_bf16 v[100:103], v[60:63], v[184:187], v[100:103]
    ds_read_b128 v[40:43], v13 offset:30720
    s_waitcnt lgkmcnt(9)
    v_mfma_f32_16x16x32_bf16 v[104:107], v[64:67], v[184:187], v[104:107]
    ds_read_b128 v[44:47], v13 offset:31744
    s_add_u32 s70, s70, 4096
    buffer_load_dwordx4 v[168:171], v11, s[36:39], s70 offen sc1
    s_waitcnt lgkmcnt(9)
    v_mfma_f32_16x16x32_bf16 v[108:111], v[68:71], v[184:187], v[108:111]
    ds_read_b128 v[48:51], v13 offset:32768
    s_waitcnt lgkmcnt(9)
    v_mfma_f32_16x16x32_bf16 v[112:115], v[72:75], v[184:187], v[112:115]
    ds_read_b128 v[52:55], v13 offset:33792
    s_waitcnt lgkmcnt(9)
    v_mfma_f32_16x16x32_bf16 v[116:119], v[76:79], v[184:187], v[116:119]
    ds_read_b128 v[56:59], v13 offset:34816
    s_waitcnt vmcnt(11)
    s_barrier
    s_add_u32 m0, s75, 0
    s_add_u32 s77, s76, 163840
    buffer_load_dwordx4 v10, s[36:39], s77 offen offset:0 sc1 lds
    buffer_load_dwordx4 v10, s[36:39], s77 offen offset:1024 sc1 lds
    buffer_load_dwordx4 v10, s[36:39], s77 offen offset:2048 sc1 lds
    buffer_load_dwordx4 v10, s[36:39], s77 offen offset:3072 sc1 lds
    s_add_u32 m0, m0, 4096
    s_add_u32 s77, s77, 4096
    buffer_load_dwordx4 v10, s[36:39], s77 offen sc1 lds
    s_waitcnt lgkmcnt(9)
    v_mfma_f32_16x16x32_bf16 v[100:103], v[20:23], v[188:191], v[100:103]
    ds_read_b128 v[60:63], v14 offset:0
    s_waitcnt lgkmcnt(9)
    v_mfma_f32_16x16x32_bf16 v[104:107], v[24:27], v[188:191], v[104:107]
    ds_read_b128 v[64:67], v14 offset:1024
    s_add_u32 s70, s70, 4096
    buffer_load_dwordx4 v[172:175], v11, s[36:39], s70 offen sc1
    s_waitcnt lgkmcnt(9)
    v_mfma_f32_16x16x32_bf16 v[108:111], v[28:31], v[188:191], v[108:111]
    ds_read_b128 v[68:71], v14 offset:2048
    s_waitcnt lgkmcnt(9)
    v_mfma_f32_16x16x32_bf16 v[112:115], v[32:35], v[188:191], v[112:115]
    ds_read_b128 v[72:75], v14 offset:3072
    s_waitcnt lgkmcnt(9)
    v_mfma_f32_16x16x32_bf16 v[116:119], v[36:39], v[188:191], v[116:119]
    ds_read_b128 v[76:79], v14 offset:4096
    s_waitcnt lgkmcnt(9)
    v_mfma_f32_16x16x32_bf16 v[100:103], v[40:43], v[192:195], v[100:103]
    ds_read_b128 v[20:23], v14 offset:10240
    s_waitcnt lgkmcnt(9)
    v_mfma_f32_16x16x32_bf16 v[104:107], v[44:47], v[192:195], v[104:107]
    ds_read_b128 v[24:27], v14 offset:11264
    s_add_u32 s70, s70, 4096
    buffer_load_dwordx4 v[176:179], v11, s[36:39], s70 offen sc1
    s_waitcnt lgkmcnt(9)
    v_mfma_f32_16x16x32_bf16 v[108:111], v[48:51], v[192:195], v[108:111]
    ds_read_b128 v[28:31], v14 offset:12288
    s_waitcnt lgkmcnt(9)
    v_mfma_f32_16x16x32_bf16 v[112:115], v[52:55], v[192:195], v[112:115]
    ds_read_b128 v[32:35], v14 offset:13312
    s_waitcnt lgkmcnt(9)
    v_mfma_f32_16x16x32_bf16 v[116:119], v[56:59], v[192:195], v[116:119]
    ds_read_b128 v[36:39], v14 offset:14336
    s_waitcnt lgkmcnt(9)
    v_mfma_f32_16x16x32_bf16 v[100:103], v[60:63], v[196:199], v[100:103]
    ds_read_b128 v[40:43], v14 offset:20480
    s_waitcnt lgkmcnt(9)
    v_mfma_f32_16x16x32_bf16 v[104:107], v[64:67], v[196:199], v[104:107]
    ds_read_b128 v[44:47], v14 offset:21504
    s_add_u32 s70, s70, 4096
    buffer_load_dwordx4 v[180:183], v11, s[36:39], s70 offen sc1
    s_waitcnt lgkmcnt(9)
    v_mfma_f32_16x16x32_bf16 v[108:111], v[68:71], v[196:199], v[108:111]
    ds_read_b128 v[48:51], v14 offset:22528
    s_waitcnt lgkmcnt(9)
    v_mfma_f32_16x16x32_bf16 v[112:115], v[72:75], v[196:199], v[112:115]
    ds_read_b128 v[52:55], v14 offset:23552
    s_waitcnt lgkmcnt(9)
    v_mfma_f32_16x16x32_bf16 v[116:119], v[76:79], v[196:199], v[116:119]
    ds_read_b128 v[56:59], v14 offset:24576
    s_lshl_b32 s48, s73, 6
    s_lshr_b32 s49, s72, 1
    s_add_u32 s48, s48, s49
    s_and_b32 s49, s72, 1
    s_lshl_b32 s49, s49, 5
    s_add_u32 s48, s48, s49
    v_and_b32 v19, 15, v1
    v_lshlrev_b32 v19, 1, v19
    v_add_u32 v19, s48, v19
    v_lshlrev_b32 v17, 2, v19
    v_add_u32 v17, 2621440, v17
    buffer_load_dword v3, v17, s[36:39], 0 offen sc1
    v_lshrrev_b32 v16, 4, v1
    s_movk_i32 s49, 1280
    v_mul_lo_u32 v19, v19, s49
    s_mul_i32 s48, s74, 160
    v_lshl_add_u32 v19, v16, 3, v19
    v_add_u32 v4, s48, v19
    v_lshlrev_b32 v17, 3, v16
    v_add_u32 v17, s48, v17
    buffer_load_dwordx2 v[80:81], v17, s[28:31], 0 offen offset:0
    buffer_load_dwordx2 v[82:83], v17, s[28:31], 0 offen offset:32
    buffer_load_dwordx2 v[84:85], v17, s[28:31], 0 offen offset:64
    buffer_load_dwordx2 v[86:87], v17, s[28:31], 0 offen offset:96
    buffer_load_dwordx2 v[88:89], v17, s[28:31], 0 offen offset:128
    s_waitcnt lgkmcnt(9)
    v_mfma_f32_16x16x32_bf16 v[100:103], v[20:23], v[200:203], v[100:103]
    ds_read_b128 v[60:63], v14 offset:30720
    s_waitcnt lgkmcnt(9)
    v_mfma_f32_16x16x32_bf16 v[104:107], v[24:27], v[200:203], v[104:107]
    ds_read_b128 v[64:67], v14 offset:31744
    s_add_u32 s70, s70, 4096
    buffer_load_dwordx4 v[184:187], v11, s[36:39], s70 offen sc1
    s_waitcnt lgkmcnt(9)
    v_mfma_f32_16x16x32_bf16 v[108:111], v[28:31], v[200:203], v[108:111]
    ds_read_b128 v[68:71], v14 offset:32768
    s_waitcnt lgkmcnt(9)
    v_mfma_f32_16x16x32_bf16 v[112:115], v[32:35], v[200:203], v[112:115]
    ds_read_b128 v[72:75], v14 offset:33792
    s_waitcnt lgkmcnt(9)
    v_mfma_f32_16x16x32_bf16 v[116:119], v[36:39], v[200:203], v[116:119]
    ds_read_b128 v[76:79], v14 offset:34816
    s_waitcnt vmcnt(19)
    s_barrier
    s_add_u32 m0, s75, 40960
    s_add_u32 s77, s76, 204800
    buffer_load_dwordx4 v10, s[36:39], s77 offen offset:0 sc1 lds
    buffer_load_dwordx4 v10, s[36:39], s77 offen offset:1024 sc1 lds
    buffer_load_dwordx4 v10, s[36:39], s77 offen offset:2048 sc1 lds
    buffer_load_dwordx4 v10, s[36:39], s77 offen offset:3072 sc1 lds
    s_add_u32 m0, m0, 4096
    s_add_u32 s77, s77, 4096
    buffer_load_dwordx4 v10, s[36:39], s77 offen sc1 lds
    s_waitcnt lgkmcnt(9)
    v_mfma_f32_16x16x32_bf16 v[100:103], v[40:43], v[204:207], v[100:103]
    ds_read_b128 v[20:23], v15 offset:0
    s_waitcnt lgkmcnt(9)
    v_mfma_f32_16x16x32_bf16 v[104:107], v[44:47], v[204:207], v[104:107]
    ds_read_b128 v[24:27], v15 offset:1024
    s_add_u32 s70, s70, 4096
    buffer_load_dwordx4 v[188:191], v11, s[36:39], s70 offen sc1
    s_waitcnt lgkmcnt(9)
    v_mfma_f32_16x16x32_bf16 v[108:111], v[48:51], v[204:207], v[108:111]
    ds_read_b128 v[28:31], v15 offset:2048
    s_waitcnt lgkmcnt(9)
    v_mfma_f32_16x16x32_bf16 v[112:115], v[52:55], v[204:207], v[112:115]
    ds_read_b128 v[32:35], v15 offset:3072
    s_waitcnt lgkmcnt(9)
    v_mfma_f32_16x16x32_bf16 v[116:119], v[56:59], v[204:207], v[116:119]
    ds_read_b128 v[36:39], v15 offset:4096
    s_waitcnt lgkmcnt(9)
    v_mfma_f32_16x16x32_bf16 v[100:103], v[60:63], v[208:211], v[100:103]
    ds_read_b128 v[40:43], v15 offset:10240
    s_waitcnt lgkmcnt(9)
    v_mfma_f32_16x16x32_bf16 v[104:107], v[64:67], v[208:211], v[104:107]
    ds_read_b128 v[44:47], v15 offset:11264
    s_waitcnt lgkmcnt(9)
    v_mfma_f32_16x16x32_bf16 v[108:111], v[68:71], v[208:211], v[108:111]
    ds_read_b128 v[48:51], v15 offset:12288
    s_waitcnt lgkmcnt(9)
    v_mfma_f32_16x16x32_bf16 v[112:115], v[72:75], v[208:211], v[112:115]
    ds_read_b128 v[52:55], v15 offset:13312
    s_waitcnt lgkmcnt(9)
    v_mfma_f32_16x16x32_bf16 v[116:119], v[76:79], v[208:211], v[116:119]
    ds_read_b128 v[56:59], v15 offset:14336
    buffer_load_dword v7, v6, s[36:39], 0 offen sc1
    s_waitcnt lgkmcnt(9)
    v_mfma_f32_16x16x32_bf16 v[100:103], v[20:23], v[212:215], v[100:103]
    ds_read_b128 v[60:63], v15 offset:20480
    s_waitcnt lgkmcnt(9)
    v_mfma_f32_16x16x32_bf16 v[104:107], v[24:27], v[212:215], v[104:107]
    ds_read_b128 v[64:67], v15 offset:21504
    s_waitcnt lgkmcnt(9)
    v_mfma_f32_16x16x32_bf16 v[108:111], v[28:31], v[212:215], v[108:111]
    ds_read_b128 v[68:71], v15 offset:22528
    s_waitcnt lgkmcnt(9)
    v_mfma_f32_16x16x32_bf16 v[112:115], v[32:35], v[212:215], v[112:115]
    ds_read_b128 v[72:75], v15 offset:23552
    s_waitcnt lgkmcnt(9)
    v_mfma_f32_16x16x32_bf16 v[116:119], v[36:39], v[212:215], v[116:119]
    ds_read_b128 v[76:79], v15 offset:24576
    s_waitcnt lgkmcnt(9)
    v_mfma_f32_16x16x32_bf16 v[100:103], v[40:43], v[216:219], v[100:103]
    ds_read_b128 v[20:23], v15 offset:30720
    s_waitcnt lgkmcnt(9)
    v_mfma_f32_16x16x32_bf16 v[104:107], v[44:47], v[216:219], v[104:107]
    ds_read_b128 v[24:27], v15 offset:31744
    s_waitcnt lgkmcnt(9)
    v_mfma_f32_16x16x32_bf16 v[108:111], v[48:51], v[216:219], v[108:111]
    ds_read_b128 v[28:31], v15 offset:32768
    s_waitcnt lgkmcnt(9)
    v_mfma_f32_16x16x32_bf16 v[112:115], v[52:55], v[216:219], v[112:115]
    ds_read_b128 v[32:35], v15 offset:33792
    s_waitcnt lgkmcnt(9)
    v_mfma_f32_16x16x32_bf16 v[116:119], v[56:59], v[216:219], v[116:119]
    ds_read_b128 v[36:39], v15 offset:34816
    s_waitcnt vmcnt(17)
    s_barrier
    s_add_u32 m0, s75, 81920
    s_add_u32 s77, s76, 245760
    buffer_load_dwordx4 v10, s[36:39], s77 offen offset:0 sc1 lds
    buffer_load_dwordx4 v10, s[36:39], s77 offen offset:1024 sc1 lds
    buffer_load_dwordx4 v10, s[36:39], s77 offen offset:2048 sc1 lds
    buffer_load_dwordx4 v10, s[36:39], s77 offen offset:3072 sc1 lds
    s_add_u32 m0, m0, 4096
    s_add_u32 s77, s77, 4096
    buffer_load_dwordx4 v10, s[36:39], s77 offen sc1 lds
    s_waitcnt lgkmcnt(9)
    v_mfma_f32_16x16x32_bf16 v[100:103], v[60:63], v[220:223], v[100:103]
    ds_read_b128 v[40:43], v12 offset:0
    s_waitcnt lgkmcnt(9)
    v_mfma_f32_16x16x32_bf16 v[104:107], v[64:67], v[220:223], v[104:107]
    ds_read_b128 v[44:47], v12 offset:1024
    s_waitcnt lgkmcnt(9)
    v_mfma_f32_16x16x32_bf16 v[108:111], v[68:71], v[220:223], v[108:111]
    ds_read_b128 v[48:51], v12 offset:2048
    s_waitcnt lgkmcnt(9)
    v_mfma_f32_16x16x32_bf16 v[112:115], v[72:75], v[220:223], v[112:115]
    ds_read_b128 v[52:55], v12 offset:3072
    s_waitcnt lgkmcnt(9)
    v_mfma_f32_16x16x32_bf16 v[116:119], v[76:79], v[220:223], v[116:119]
    ds_read_b128 v[56:59], v12 offset:4096
    s_waitcnt lgkmcnt(9)
    v_mfma_f32_16x16x32_bf16 v[100:103], v[20:23], v[224:227], v[100:103]
    ds_read_b128 v[60:63], v12 offset:10240
    s_waitcnt lgkmcnt(9)
    v_mfma_f32_16x16x32_bf16 v[104:107], v[24:27], v[224:227], v[104:107]
    ds_read_b128 v[64:67], v12 offset:11264
    s_waitcnt lgkmcnt(9)
    v_mfma_f32_16x16x32_bf16 v[108:111], v[28:31], v[224:227], v[108:111]
    ds_read_b128 v[68:71], v12 offset:12288
    s_waitcnt lgkmcnt(9)
    v_mfma_f32_16x16x32_bf16 v[112:115], v[32:35], v[224:227], v[112:115]
    ds_read_b128 v[72:75], v12 offset:13312
    s_waitcnt lgkmcnt(9)
    v_mfma_f32_16x16x32_bf16 v[116:119], v[36:39], v[224:227], v[116:119]
    ds_read_b128 v[76:79], v12 offset:14336
    s_waitcnt vmcnt(5)
    v_cmp_ne_u32 vcc, s96, v7
    s_nop 4
    s_cbranch_vccz pc_19_ok
pc_19:
    s_sleep 1
    buffer_load_dword v7, v6, s[36:39], 0 offen sc1
    s_waitcnt vmcnt(0)
    v_cmp_ne_u32 vcc, s96, v7
    s_nop 4
    s_cbranch_vccnz pc_19
pc_19_ok:
    s_waitcnt lgkmcnt(9)
    v_mfma_f32_16x16x32_bf16 v[100:103], v[40:43], v[228:231], v[100:103]
    ds_read_b128 v[20:23], v12 offset:20480
    s_waitcnt lgkmcnt(9)
    v_mfma_f32_16x16x32_bf16 v[104:107], v[44:47], v[228:231], v[104:107]
    ds_read_b128 v[24:27], v12 offset:21504
    buffer_load_dwordx4 v[192:195], v11, s[36:39], s71 offen sc1
    s_waitcnt lgkmcnt(9)
    v_mfma_f32_16x16x32_bf16 v[108:111], v[48:51], v[228:231], v[108:111]
    ds_read_b128 v[28:31], v12 offset:22528
    s_waitcnt lgkmcnt(9)
    v_mfma_f32_16x16x32_bf16 v[112:115], v[52:55], v[228:231], v[112:115]
    ds_read_b128 v[32:35], v12 offset:23552
    s_add_u32 s71, s71, 4096
    buffer_load_dwordx4 v[196:199], v11, s[36:39], s71 offen sc1
    s_waitcnt lgkmcnt(9)
    v_mfma_f32_16x16x32_bf16 v[116:119], v[56:59], v[228:231], v[116:119]
    ds_read_b128 v[36:39], v12 offset:24576
    s_waitcnt lgkmcnt(9)
    v_mfma_f32_16x16x32_bf16 v[100:103], v[60:63], v[232:235], v[100:103]
    ds_read_b128 v[40:43], v12 offset:30720
    s_waitcnt lgkmcnt(9)
    v_mfma_f32_16x16x32_bf16 v[104:107], v[64:67], v[232:235], v[104:107]
    ds_read_b128 v[44:47], v12 offset:31744
    s_add_u32 s71, s71, 4096
    buffer_load_dwordx4 v[200:203], v11, s[36:39], s71 offen sc1
    s_waitcnt lgkmcnt(9)
    v_mfma_f32_16x16x32_bf16 v[108:111], v[68:71], v[232:235], v[108:111]
    ds_read_b128 v[48:51], v12 offset:32768
    s_waitcnt lgkmcnt(9)
    v_mfma_f32_16x16x32_bf16 v[112:115], v[72:75], v[232:235], v[112:115]
    ds_read_b128 v[52:55], v12 offset:33792
    s_add_u32 s71, s71, 4096
    buffer_load_dwordx4 v[204:207], v11, s[36:39], s71 offen sc1
    s_waitcnt lgkmcnt(9)
    v_mfma_f32_16x16x32_bf16 v[116:119], v[76:79], v[232:235], v[116:119]
    ds_read_b128 v[56:59], v12 offset:34816
    s_barrier
    s_add_u32 m0, s75, 122880
    s_add_u32 s77, s76, 286720
    buffer_load_dwordx4 v10, s[36:39], s77 offen offset:0 sc1 lds
    buffer_load_dwordx4 v10, s[36:39], s77 offen offset:1024 sc1 lds
    buffer_load_dwordx4 v10, s[36:39], s77 offen offset:2048 sc1 lds
    buffer_load_dwordx4 v10, s[36:39], s77 offen offset:3072 sc1 lds
    s_add_u32 m0, m0, 4096
    s_add_u32 s77, s77, 4096
    buffer_load_dwordx4 v10, s[36:39], s77 offen sc1 lds
    s_waitcnt lgkmcnt(9)
    v_mfma_f32_16x16x32_bf16 v[100:103], v[20:23], v[236:239], v[100:103]
    ds_read_b128 v[60:63], v13 offset:0
    s_waitcnt lgkmcnt(9)
    v_mfma_f32_16x16x32_bf16 v[104:107], v[24:27], v[236:239], v[104:107]
    ds_read_b128 v[64:67], v13 offset:1024
    s_add_u32 s71, s71, 4096
    buffer_load_dwordx4 v[208:211], v11, s[36:39], s71 offen sc1
    s_waitcnt lgkmcnt(9)
    v_mfma_f32_16x16x32_bf16 v[108:111], v[28:31], v[236:239], v[108:111]
    ds_read_b128 v[68:71], v13 offset:2048
    s_waitcnt lgkmcnt(9)
    v_mfma_f32_16x16x32_bf16 v[112:115], v[32:35], v[236:239], v[112:115]
    ds_read_b128 v[72:75], v13 offset:3072
    s_add_u32 s71, s71, 4096
    buffer_load_dwordx4 v[212:215], v11, s[36:39], s71 offen sc1
    s_waitcnt lgkmcnt(9)
    v_mfma_f32_16x16x32_bf16 v[116:119], v[36:39], v[236:239], v[116:119]
    ds_read_b128 v[76:79], v13 offset:4096
    s_waitcnt lgkmcnt(9)
    v_mfma_f32_16x16x32_bf16 v[100:103], v[40:43], v[240:243], v[100:103]
    ds_read_b128 v[20:23], v13 offset:10240
    s_waitcnt lgkmcnt(9)
    v_mfma_f32_16x16x32_bf16 v[104:107], v[44:47], v[240:243], v[104:107]
    ds_read_b128 v[24:27], v13 offset:11264
    s_add_u32 s71, s71, 4096
    buffer_load_dwordx4 v[216:219], v11, s[36:39], s71 offen sc1
    s_waitcnt lgkmcnt(9)
    v_mfma_f32_16x16x32_bf16 v[108:111], v[48:51], v[240:243], v[108:111]
    ds_read_b128 v[28:31], v13 offset:12288
    s_waitcnt lgkmcnt(9)
    v_mfma_f32_16x16x32_bf16 v[112:115], v[52:55], v[240:243], v[112:115]
    ds_read_b128 v[32:35], v13 offset:13312
    s_add_u32 s71, s71, 4096
    buffer_load_dwordx4 v[220:223], v11, s[36:39], s71 offen sc1
    s_waitcnt lgkmcnt(9)
    v_mfma_f32_16x16x32_bf16 v[116:119], v[56:59], v[240:243], v[116:119]
    ds_read_b128 v[36:39], v13 offset:14336
    s_waitcnt lgkmcnt(9)
    v_mfma_f32_16x16x32_bf16 v[100:103], v[60:63], v[164:167], v[100:103]
    ds_read_b128 v[40:43], v13 offset:20480
    s_waitcnt lgkmcnt(9)
    v_mfma_f32_16x16x32_bf16 v[104:107], v[64:67], v[164:167], v[104:107]
    ds_read_b128 v[44:47], v13 offset:21504
    s_add_u32 s71, s71, 4096
    buffer_load_dwordx4 v[224:227], v11, s[36:39], s71 offen sc1
    s_waitcnt lgkmcnt(9)
    v_mfma_f32_16x16x32_bf16 v[108:111], v[68:71], v[164:167], v[108:111]
    ds_read_b128 v[48:51], v13 offset:22528
    s_waitcnt lgkmcnt(9)
    v_mfma_f32_16x16x32_bf16 v[112:115], v[72:75], v[164:167], v[112:115]
    ds_read_b128 v[52:55], v13 offset:23552
    s_add_u32 s71, s71, 4096
    buffer_load_dwordx4 v[228:231], v11, s[36:39], s71 offen sc1
    s_waitcnt lgkmcnt(9)
    v_mfma_f32_16x16x32_bf16 v[116:119], v[76:79], v[164:167], v[116:119]
    ds_read_b128 v[56:59], v13 offset:24576
    s_waitcnt lgkmcnt(9)
    v_mfma_f32_16x16x32_bf16 v[100:103], v[20:23], v[168:171], v[100:103]
    ds_read_b128 v[60:63], v13 offset:30720
    s_waitcnt lgkmcnt(9)
    v_mfma_f32_16x16x32_bf16 v[104:107], v[24:27], v[168:171], v[104:107]
    ds_read_b128 v[64:67], v13 offset:31744
    s_waitcnt lgkmcnt(9)
    v_mfma_f32_16x16x32_bf16 v[108:111], v[28:31], v[168:171], v[108:111]
    ds_read_b128 v[68:71], v13 offset:32768
    s_waitcnt lgkmcnt(9)
    v_mfma_f32_16x16x32_bf16 v[112:115], v[32:35], v[168:171], v[112:115]
    ds_read_b128 v[72:75], v13 offset:33792
    s_waitcnt lgkmcnt(9)
    v_mfma_f32_16x16x32_bf16 v[116:119], v[36:39], v[168:171], v[116:119]
    ds_read_b128 v[76:79], v13 offset:34816
    s_waitcnt vmcnt(15)
    s_barrier
    s_add_u32 m0, s75, 0
    s_add_u32 s77, s76, 327680
    buffer_load_dwordx4 v10, s[36:39], s77 offen offset:0 sc1 lds
    buffer_load_dwordx4 v10, s[36:39], s77 offen offset:1024 sc1 lds
    buffer_load_dwordx4 v10, s[36:39], s77 offen offset:2048 sc1 lds
    buffer_load_dwordx4 v10, s[36:39], s77 offen offset:3072 sc1 lds
    s_add_u32 m0, m0, 4096
    s_add_u32 s77, s77, 4096
    buffer_load_dwordx4 v10, s[36:39], s77 offen sc1 lds
    s_waitcnt lgkmcnt(9)
    v_mfma_f32_16x16x32_bf16 v[100:103], v[40:43], v[172:175], v[100:103]
    ds_read_b128 v[20:23], v14 offset:0
    s_waitcnt lgkmcnt(9)
    v_mfma_f32_16x16x32_bf16 v[104:107], v[44:47], v[172:175], v[104:107]
    ds_read_b128 v[24:27], v14 offset:1024
    s_waitcnt lgkmcnt(9)
    v_mfma_f32_16x16x32_bf16 v[108:111], v[48:51], v[172:175], v[108:111]
    ds_read_b128 v[28:31], v14 offset:2048
    s_waitcnt lgkmcnt(9)
    v_mfma_f32_16x16x32_bf16 v[112:115], v[52:55], v[172:175], v[112:115]
    ds_read_b128 v[32:35], v14 offset:3072
    s_waitcnt lgkmcnt(9)
    v_mfma_f32_16x16x32_bf16 v[116:119], v[56:59], v[172:175], v[116:119]
    ds_read_b128 v[36:39], v14 offset:4096
    s_waitcnt lgkmcnt(9)
    v_mfma_f32_16x16x32_bf16 v[100:103], v[60:63], v[176:179], v[100:103]
    ds_read_b128 v[40:43], v14 offset:10240
    s_waitcnt lgkmcnt(9)
    v_mfma_f32_16x16x32_bf16 v[104:107], v[64:67], v[176:179], v[104:107]
    ds_read_b128 v[44:47], v14 offset:11264
    s_waitcnt lgkmcnt(9)
    v_mfma_f32_16x16x32_bf16 v[108:111], v[68:71], v[176:179], v[108:111]
    ds_read_b128 v[48:51], v14 offset:12288
    s_waitcnt lgkmcnt(9)
    v_mfma_f32_16x16x32_bf16 v[112:115], v[72:75], v[176:179], v[112:115]
    ds_read_b128 v[52:55], v14 offset:13312
    s_waitcnt lgkmcnt(9)
    v_mfma_f32_16x16x32_bf16 v[116:119], v[76:79], v[176:179], v[116:119]
    ds_read_b128 v[56:59], v14 offset:14336
    s_waitcnt lgkmcnt(9)
    v_mfma_f32_16x16x32_bf16 v[100:103], v[20:23], v[180:183], v[100:103]
    ds_read_b128 v[60:63], v14 offset:20480
    s_waitcnt lgkmcnt(9)
    v_mfma_f32_16x16x32_bf16 v[104:107], v[24:27], v[180:183], v[104:107]
    ds_read_b128 v[64:67], v14 offset:21504
    s_waitcnt lgkmcnt(9)
    v_mfma_f32_16x16x32_bf16 v[108:111], v[28:31], v[180:183], v[108:111]
    ds_read_b128 v[68:71], v14 offset:22528
    s_waitcnt lgkmcnt(9)
    v_mfma_f32_16x16x32_bf16 v[112:115], v[32:35], v[180:183], v[112:115]
    ds_read_b128 v[72:75], v14 offset:23552
    s_waitcnt lgkmcnt(9)
    v_mfma_f32_16x16x32_bf16 v[116:119], v[36:39], v[180:183], v[116:119]
    ds_read_b128 v[76:79], v14 offset:24576
    s_waitcnt lgkmcnt(9)
    v_mfma_f32_16x16x32_bf16 v[100:103], v[40:43], v[184:187], v[100:103]
    ds_read_b128 v[20:23], v14 offset:30720
    s_waitcnt lgkmcnt(9)
    v_mfma_f32_16x16x32_bf16 v[104:107], v[44:47], v[184:187], v[104:107]
    ds_read_b128 v[24:27], v14 offset:31744
    s_waitcnt lgkmcnt(9)
    v_mfma_f32_16x16x32_bf16 v[108:111], v[48:51], v[184:187], v[108:111]
    ds_read_b128 v[28:31], v14 offset:32768
    s_waitcnt lgkmcnt(9)
    v_mfma_f32_16x16x32_bf16 v[112:115], v[52:55], v[184:187], v[112:115]
    ds_read_b128 v[32:35], v14 offset:33792
    s_waitcnt lgkmcnt(9)
    v_mfma_f32_16x16x32_bf16 v[116:119], v[56:59], v[184:187], v[116:119]
    ds_read_b128 v[36:39], v14 offset:34816
    s_waitcnt vmcnt(11)
    s_barrier
    s_add_u32 m0, s75, 40960
    s_add_u32 s77, s76, 368640
    s_cmp_ge_u32 s44, 2
    s_cselect_b32 s77, 0x7fff0000, s77
    buffer_load_dwordx4 v10, s[36:39], s77 offen offset:0 sc1 lds
    buffer_load_dwordx4 v10, s[36:39], s77 offen offset:1024 sc1 lds
    buffer_load_dwordx4 v10, s[36:39], s77 offen offset:2048 sc1 lds
    buffer_load_dwordx4 v10, s[36:39], s77 offen offset:3072 sc1 lds
    s_add_u32 m0, m0, 4096
    s_add_u32 s77, s77, 4096
    buffer_load_dwordx4 v10, s[36:39], s77 offen sc1 lds
    s_waitcnt lgkmcnt(9)
    v_mfma_f32_16x16x32_bf16 v[100:103], v[60:63], v[188:191], v[100:103]
    ds_read_b128 v[40:43], v15 offset:0
    s_waitcnt lgkmcnt(9)
    v_mfma_f32_16x16x32_bf16 v[104:107], v[64:67], v[188:191], v[104:107]
    ds_read_b128 v[44:47], v15 offset:1024
    s_waitcnt lgkmcnt(9)
    v_mfma_f32_16x16x32_bf16 v[108:111], v[68:71], v[188:191], v[108:111]
    ds_read_b128 v[48:51], v15 offset:2048
    s_waitcnt lgkmcnt(9)
    v_mfma_f32_16x16x32_bf16 v[112:115], v[72:75], v[188:191], v[112:115]
    ds_read_b128 v[52:55], v15 offset:3072
    s_waitcnt lgkmcnt(9)
    v_mfma_f32_16x16x32_bf16 v[116:119], v[76:79], v[188:191], v[116:119]
    ds_read_b128 v[56:59], v15 offset:4096
    s_waitcnt lgkmcnt(9)
    v_mfma_f32_16x16x32_bf16 v[120:123], v[20:23], v[192:195], 0
    ds_read_b128 v[60:63], v15 offset:10240
    s_waitcnt lgkmcnt(9)
    v_mfma_f32_16x16x32_bf16 v[124:127], v[24:27], v[192:195], 0
    ds_read_b128 v[64:67], v15 offset:11264
    s_waitcnt lgkmcnt(9)
    v_mfma_f32_16x16x32_bf16 v[128:131], v[28:31], v[192:195], 0
    ds_read_b128 v[68:71], v15 offset:12288
    s_waitcnt lgkmcnt(9)
    v_mfma_f32_16x16x32_bf16 v[132:135], v[32:35], v[192:195], 0
    ds_read_b128 v[72:75], v15 offset:13312
    s_waitcnt lgkmcnt(9)
    v_mfma_f32_16x16x32_bf16 v[136:139], v[36:39], v[192:195], 0
    ds_read_b128 v[76:79], v15 offset:14336
    s_waitcnt lgkmcnt(9)
    v_mfma_f32_16x16x32_bf16 v[120:123], v[40:43], v[196:199], v[120:123]
    ds_read_b128 v[20:23], v15 offset:20480
    s_waitcnt lgkmcnt(9)
    v_mfma_f32_16x16x32_bf16 v[124:127], v[44:47], v[196:199], v[124:127]
    ds_read_b128 v[24:27], v15 offset:21504
    s_waitcnt lgkmcnt(9)
    v_mfma_f32_16x16x32_bf16 v[128:131], v[48:51], v[196:199], v[128:131]
    ds_read_b128 v[28:31], v15 offset:22528
    s_waitcnt lgkmcnt(9)
    v_mfma_f32_16x16x32_bf16 v[132:135], v[52:55], v[196:199], v[132:135]
    ds_read_b128 v[32:35], v15 offset:23552
    s_waitcnt lgkmcnt(9)
    v_mfma_f32_16x16x32_bf16 v[136:139], v[56:59], v[196:199], v[136:139]
    ds_read_b128 v[36:39], v15 offset:24576
    s_waitcnt lgkmcnt(9)
    v_mfma_f32_16x16x32_bf16 v[120:123], v[60:63], v[200:203], v[120:123]
    ds_read_b128 v[40:43], v15 offset:30720
    s_waitcnt lgkmcnt(9)
    v_mfma_f32_16x16x32_bf16 v[124:127], v[64:67], v[200:203], v[124:127]
    ds_read_b128 v[44:47], v15 offset:31744
    s_waitcnt lgkmcnt(9)
    v_mfma_f32_16x16x32_bf16 v[128:131], v[68:71], v[200:203], v[128:131]
    ds_read_b128 v[48:51], v15 offset:32768
    s_waitcnt lgkmcnt(9)
    v_mfma_f32_16x16x32_bf16 v[132:135], v[72:75], v[200:203], v[132:135]
    ds_read_b128 v[52:55], v15 offset:33792
    s_waitcnt lgkmcnt(9)
    v_mfma_f32_16x16x32_bf16 v[136:139], v[76:79], v[200:203], v[136:139]
    ds_read_b128 v[56:59], v15 offset:34816
    s_waitcnt vmcnt(5)
    s_barrier
    s_waitcnt lgkmcnt(9)
    v_mfma_f32_16x16x32_bf16 v[120:123], v[20:23], v[204:207], v[120:123]
    ds_read_b128 v[60:63], v12 offset:0
    s_waitcnt lgkmcnt(9)
    v_mfma_f32_16x16x32_bf16 v[124:127], v[24:27], v[204:207], v[124:127]
    ds_read_b128 v[64:67], v12 offset:1024
    s_waitcnt lgkmcnt(9)
    v_mfma_f32_16x16x32_bf16 v[128:131], v[28:31], v[204:207], v[128:131]
    ds_read_b128 v[68:71], v12 offset:2048
    s_waitcnt lgkmcnt(9)
    v_mfma_f32_16x16x32_bf16 v[132:135], v[32:35], v[204:207], v[132:135]
    ds_read_b128 v[72:75], v12 offset:3072
    s_waitcnt lgkmcnt(9)
    v_mfma_f32_16x16x32_bf16 v[136:139], v[36:39], v[204:207], v[136:139]
    ds_read_b128 v[76:79], v12 offset:4096
    s_waitcnt lgkmcnt(9)
    v_mfma_f32_16x16x32_bf16 v[120:123], v[40:43], v[208:211], v[120:123]
    ds_read_b128 v[20:23], v12 offset:10240
    s_waitcnt lgkmcnt(9)
    v_mfma_f32_16x16x32_bf16 v[124:127], v[44:47], v[208:211], v[124:127]
    ds_read_b128 v[24:27], v12 offset:11264
    s_waitcnt lgkmcnt(9)
    v_mfma_f32_16x16x32_bf16 v[128:131], v[48:51], v[208:211], v[128:131]
    ds_read_b128 v[28:31], v12 offset:12288
    s_waitcnt lgkmcnt(9)
    v_mfma_f32_16x16x32_bf16 v[132:135], v[52:55], v[208:211], v[132:135]
    ds_read_b128 v[32:35], v12 offset:13312
    s_waitcnt lgkmcnt(9)
    v_mfma_f32_16x16x32_bf16 v[136:139], v[56:59], v[208:211], v[136:139]
    ds_read_b128 v[36:39], v12 offset:14336
    s_waitcnt lgkmcnt(9)
    v_mfma_f32_16x16x32_bf16 v[120:123], v[60:63], v[212:215], v[120:123]
    ds_read_b128 v[40:43], v12 offset:20480
    s_waitcnt lgkmcnt(9)
    v_mfma_f32_16x16x32_bf16 v[124:127], v[64:67], v[212:215], v[124:127]
    ds_read_b128 v[44:47], v12 offset:21504
    s_waitcnt lgkmcnt(9)
    v_mfma_f32_16x16x32_bf16 v[128:131], v[68:71], v[212:215], v[128:131]
    ds_read_b128 v[48:51], v12 offset:22528
    s_waitcnt lgkmcnt(9)
    v_mfma_f32_16x16x32_bf16 v[132:135], v[72:75], v[212:215], v[132:135]
    ds_read_b128 v[52:55], v12 offset:23552
    s_waitcnt lgkmcnt(9)
    v_mfma_f32_16x16x32_bf16 v[136:139], v[76:79], v[212:215], v[136:139]
    ds_read_b128 v[56:59], v12 offset:24576
    s_waitcnt lgkmcnt(9)
    v_mfma_f32_16x16x32_bf16 v[120:123], v[20:23], v[216:219], v[120:123]
    ds_read_b128 v[60:63], v12 offset:30720
    s_waitcnt lgkmcnt(9)
    v_mfma_f32_16x16x32_bf16 v[124:127], v[24:27], v[216:219], v[124:127]
    ds_read_b128 v[64:67], v12 offset:31744
    s_waitcnt lgkmcnt(9)
    v_mfma_f32_16x16x32_bf16 v[128:131], v[28:31], v[216:219], v[128:131]
    ds_read_b128 v[68:71], v12 offset:32768
    s_waitcnt lgkmcnt(9)
    v_mfma_f32_16x16x32_bf16 v[132:135], v[32:35], v[216:219], v[132:135]
    ds_read_b128 v[72:75], v12 offset:33792
    s_waitcnt lgkmcnt(9)
    v_mfma_f32_16x16x32_bf16 v[136:139], v[36:39], v[216:219], v[136:139]
    ds_read_b128 v[76:79], v12 offset:34816
    s_waitcnt vmcnt(0)
    s_barrier
    s_waitcnt lgkmcnt(9)
    v_mfma_f32_16x16x32_bf16 v[120:123], v[40:43], v[220:223], v[120:123]
    ds_read_b128 v[20:23], v13 offset:0
    s_waitcnt lgkmcnt(9)
    v_mfma_f32_16x16x32_bf16 v[124:127], v[44:47], v[220:223], v[124:127]
    ds_read_b128 v[24:27], v13 offset:1024
    s_waitcnt lgkmcnt(9)
    v_mfma_f32_16x16x32_bf16 v[128:131], v[48:51], v[220:223], v[128:131]
    ds_read_b128 v[28:31], v13 offset:2048
    s_waitcnt lgkmcnt(9)
    v_mfma_f32_16x16x32_bf16 v[132:135], v[52:55], v[220:223], v[132:135]
    ds_read_b128 v[32:35], v13 offset:3072
    s_waitcnt lgkmcnt(9)
    v_mfma_f32_16x16x32_bf16 v[136:139], v[56:59], v[220:223], v[136:139]
    ds_read_b128 v[36:39], v13 offset:4096
    s_waitcnt lgkmcnt(9)
    v_mfma_f32_16x16x32_bf16 v[120:123], v[60:63], v[224:227], v[120:123]
    s_waitcnt lgkmcnt(8)
    v_mfma_f32_16x16x32_bf16 v[124:127], v[64:67], v[224:227], v[124:127]
    s_waitcnt lgkmcnt(7)
    v_mfma_f32_16x16x32_bf16 v[128:131], v[68:71], v[224:227], v[128:131]
    s_waitcnt lgkmcnt(6)
    v_mfma_f32_16x16x32_bf16 v[132:135], v[72:75], v[224:227], v[132:135]
    s_waitcnt lgkmcnt(5)
    v_mfma_f32_16x16x32_bf16 v[136:139], v[76:79], v[224:227], v[136:139]
    s_waitcnt lgkmcnt(4)
    v_mfma_f32_16x16x32_bf16 v[120:123], v[20:23], v[228:231], v[120:123]
    s_waitcnt lgkmcnt(3)
    v_mfma_f32_16x16x32_bf16 v[124:127], v[24:27], v[228:231], v[124:127]
    s_waitcnt lgkmcnt(2)
    v_mfma_f32_16x16x32_bf16 v[128:131], v[28:31], v[228:231], v[128:131]
    s_waitcnt lgkmcnt(1)
    v_mfma_f32_16x16x32_bf16 v[132:135], v[32:35], v[228:231], v[132:135]
    s_waitcnt lgkmcnt(0)
    v_mfma_f32_16x16x32_bf16 v[136:139], v[36:39], v[228:231], v[136:139]
    v_sub_f32 v16, 1.0, v3
    s_cmp_lg_u32 s81, 0
    s_cbranch_scc1 bi_20
    v_lshlrev_b32 v18, 16, v80
    v_and_b32 v19, 0xffff0000, v80
    v_add_f32 v100, v100, v18
    v_add_f32 v101, v101, v19
    v_lshlrev_b32 v18, 16, v81
    v_and_b32 v19, 0xffff0000, v81
    v_add_f32 v102, v102, v18
    v_add_f32 v103, v103, v19
    v_lshlrev_b32 v18, 16, v82
    v_and_b32 v19, 0xffff0000, v82
    v_add_f32 v104, v104, v18
    v_add_f32 v105, v105, v19
    v_lshlrev_b32 v18, 16, v83
    v_and_b32 v19, 0xffff0000, v83
    v_add_f32 v106, v106, v18
    v_add_f32 v107, v107, v19
    v_lshlrev_b32 v18, 16, v84
    v_and_b32 v19, 0xffff0000, v84
    v_add_f32 v108, v108, v18
    v_add_f32 v109, v109, v19
    v_lshlrev_b32 v18, 16, v85
    v_and_b32 v19, 0xffff0000, v85
    v_add_f32 v110, v110, v18
    v_add_f32 v111, v111, v19
    v_lshlrev_b32 v18, 16, v86
    v_and_b32 v19, 0xffff0000, v86
    v_add_f32 v112, v112, v18
    v_add_f32 v113, v113, v19
    v_lshlrev_b32 v18, 16, v87
    v_and_b32 v19, 0xffff0000, v87
    v_add_f32 v114, v114, v18
    v_add_f32 v115, v115, v19
    v_lshlrev_b32 v18, 16, v88
    v_and_b32 v19, 0xffff0000, v88
    v_add_f32 v116, v116, v18
    v_add_f32 v117, v117, v19
    v_lshlrev_b32 v18, 16, v89
    v_and_b32 v19, 0xffff0000, v89
    v_add_f32 v118, v118, v18
    v_add_f32 v119, v119, v19
bi_20:
    v_mul_f32 v100, v100, v16
    v_mul_f32 v101, v101, v16
    v_mul_f32 v102, v102, v16
    v_mul_f32 v103, v103, v16
    v_mul_f32 v104, v104, v16
    v_mul_f32 v105, v105, v16
    v_mul_f32 v106, v106, v16
    v_mul_f32 v107, v107, v16
    v_mul_f32 v108, v108, v16
    v_mul_f32 v109, v109, v16
    v_mul_f32 v110, v110, v16
    v_mul_f32 v111, v111, v16
    v_mul_f32 v112, v112, v16
    v_mul_f32 v113, v113, v16
    v_mul_f32 v114, v114, v16
    v_mul_f32 v115, v115, v16
    v_mul_f32 v116, v116, v16
    v_mul_f32 v117, v117, v16
    v_mul_f32 v118, v118, v16
    v_mul_f32 v119, v119, v16
    v_fmac_f32 v100, v120, v3
    v_fmac_f32 v101, v121, v3
    v_fmac_f32 v102, v122, v3
    v_fmac_f32 v103, v123, v3
    v_fmac_f32 v104, v124, v3
    v_fmac_f32 v105, v125, v3
    v_fmac_f32 v106, v126, v3
    v_fmac_f32 v107, v127, v3
    v_fmac_f32 v108, v128, v3
    v_fmac_f32 v109, v129, v3
    v_fmac_f32 v110, v130, v3
    v_fmac_f32 v111, v131, v3
    v_fmac_f32 v112, v132, v3
    v_fmac_f32 v113, v133, v3
    v_fmac_f32 v114, v134, v3
    v_fmac_f32 v115, v135, v3
    v_fmac_f32 v116, v136, v3
    v_fmac_f32 v117, v137, v3
    v_fmac_f32 v118, v138, v3
    v_fmac_f32 v119, v139, v3
    v_lshlrev_b32 v17, 4, v1
    s_mul_i32 s48, s72, 5120
    s_add_u32 s48, s48, 81920
    v_add_u32 v17, s48, v17
    s_cmp_eq_u32 s81, 0
    s_cbranch_scc1 rd_21
    ds_write_b128 v17, v[100:103] offset:0
    ds_write_b128 v17, v[104:107] offset:1024
    ds_write_b128 v17, v[108:111] offset:2048
    s_waitcnt lgkmcnt(0)
    s_barrier
    ds_read_b128 v[132:135], v17 offset:3072
    ds_read_b128 v[136:139], v17 offset:4096
    s_waitcnt lgkmcnt(1)
    v_add_f32 v112, v112, v132
    v_add_f32 v113, v113, v133
    v_add_f32 v114, v114, v134
    v_add_f32 v115, v115, v135
    v_cvt_pk_bf16_f32 v26, v112, v113
    v_cvt_pk_bf16_f32 v27, v114, v115
    buffer_store_dwordx2 v[26:27], v4, s[32:35], 0 offen offset:96
    s_waitcnt lgkmcnt(0)
    v_add_f32 v116, v116, v136
    v_add_f32 v117, v117, v137
    v_add_f32 v118, v118, v138
    v_add_f32 v119, v119, v139
    v_cvt_pk_bf16_f32 v28, v116, v117
    v_cvt_pk_bf16_f32 v29, v118, v119
    buffer_store_dwordx2 v[28:29], v4, s[32:35], 0 offen offset:128
    s_endpgm
rd_21:
    ds_write_b128 v17, v[112:115] offset:3072
    ds_write_b128 v17, v[116:119] offset:4096
    s_waitcnt lgkmcnt(0)
    s_barrier
    ds_read_b128 v[120:123], v17 offset:0
    ds_read_b128 v[124:127], v17 offset:1024
    ds_read_b128 v[128:131], v17 offset:2048
    s_waitcnt lgkmcnt(2)
    v_add_f32 v100, v100, v120
    v_add_f32 v101, v101, v121
    v_add_f32 v102, v102, v122
    v_add_f32 v103, v103, v123
    v_cvt_pk_bf16_f32 v20, v100, v101
    v_cvt_pk_bf16_f32 v21, v102, v103
    buffer_store_dwordx2 v[20:21], v4, s[32:35], 0 offen offset:0
    s_waitcnt lgkmcnt(1)
    v_add_f32 v104, v104, v124
    v_add_f32 v105, v105, v125
    v_add_f32 v106, v106, v126
    v_add_f32 v107, v107, v127
    v_cvt_pk_bf16_f32 v22, v104, v105
    v_cvt_pk_bf16_f32 v23, v106, v107
    buffer_store_dwordx2 v[22:23], v4, s[32:35], 0 offen offset:32
    s_waitcnt lgkmcnt(0)
    v_add_f32 v108, v108, v128
    v_add_f32 v109, v109, v129
    v_add_f32 v110, v110, v130
    v_add_f32 v111, v111, v131
    v_cvt_pk_bf16_f32 v24, v108, v109
    v_cvt_pk_bf16_f32 v25, v110, v111
    buffer_store_dwordx2 v[24:25], v4, s[32:35], 0 offen offset:64
L_end:
    s_endpgm
.section .rodata,"a"
.p2align 6
.amdhsa_kernel gated_mix__sliding_block__mixer_channel_mlp__prompt_kernel
  .amdhsa_next_free_vgpr 256
  .amdhsa_next_free_sgpr 102
  .amdhsa_accum_offset 256
  .amdhsa_group_segment_fixed_size 0
  .amdhsa_kernarg_size 96
  .amdhsa_user_sgpr_count 2
  .amdhsa_user_sgpr_kernarg_segment_ptr 1
  .amdhsa_system_sgpr_workgroup_id_x 1
.end_amdhsa_kernel
```
